```python
import torch

def _softmax(x, axis=-1):
    return torch.softmax(x, dim=axis)
def _gelu(x):
    return torch.nn.functional.gelu(x, approximate="tanh")
def _silu(x):
    return torch.nn.functional.silu(x)
def _sigmoid(x):
    return torch.sigmoid(x)
def _layernorm(x, axis=-1, eps=1e-5):
    m = x.mean(dim=axis, keepdim=True)
    v = x.var(dim=axis, keepdim=True, unbiased=False)
    return (x - m) / torch.sqrt(v + eps)
def _scatter_add(tgt, idx, src, axis=0):
    return tgt.clone().index_add_(axis, idx, src)
def _segment_sum(src, seg, n):
    out = torch.zeros((n,) + src.shape[1:], dtype=src.dtype)
    return out.index_add_(0, seg, src)
def _pad(x, pw):
    flat = tuple(v for pair in reversed(pw) for v in pair)
    return torch.nn.functional.pad(x, flat)

kernel_name = 'concat_heads__mha_block_cached__gqa_block_cached__near_ridge'

def setup_inputs():

    _w = (lambda a: (lambda t: t.to(torch.bfloat16) if t.is_floating_point() else t)(torch.as_tensor(a)))
    def _A_setup():
        B, Sq, D = 16, 128, 512
        H, Sk, Dh = 32, 512, 128
        return {
            "x": _w((lambda *s: torch.randn(*s, dtype=torch.bfloat16) * 0.8)(B, Sq, D)),
            "k_cache": _w((lambda *s: torch.randn(*s, dtype=torch.bfloat16) * 0.8)(B, H, Sk, Dh)),
            "v_cache": _w((lambda *s: torch.randn(*s, dtype=torch.bfloat16) * 0.05)(B, H, Sk, Dh)),
            "wq": _w((lambda *s: torch.randn(*s, dtype=torch.bfloat16) * 0.8)(D, H * Dh) * (D ** -0.5)),
            "wo": _w((lambda *s: torch.randn(*s, dtype=torch.bfloat16) * 0.05)(H * Dh, D) * ((H * Dh) ** -0.5)),
        }
    _A_in = _A_setup()

    def _B_setup():
        B, Sq, D = 16, 128, 512
        Hq, Hkv, Sk, Dh = 32, 32, 512, 128
        assert Hq % Hkv == 0, (Hq, Hkv)
        return {
            "x": _w((lambda *s: torch.randn(*s, dtype=torch.bfloat16) * 0.8)(B, Sq, D)),
            "k_cache": _w((lambda *s: torch.randn(*s, dtype=torch.bfloat16) * 0.8)(B, Hkv, Sk, Dh)),
            "v_cache": _w((lambda *s: torch.randn(*s, dtype=torch.bfloat16) * 0.05)(B, Hkv, Sk, Dh)),
            "wq": _w((lambda *s: torch.randn(*s, dtype=torch.bfloat16) * 0.8)(D, Hq * Dh) * (D ** -0.5)),
            "wo": _w((lambda *s: torch.randn(*s, dtype=torch.bfloat16) * 0.05)(Hq * Dh, D) * ((Hq * Dh) ** -0.5)),
        }
    _B_in = _B_setup()

    return {
        "A_x": _A_in["x"],
        "A_k_cache": _A_in["k_cache"],
        "A_v_cache": _A_in["v_cache"],
        "A_wq": _A_in["wq"],
        "A_wo": _A_in["wo"],
        "B_x": _B_in["x"],
        "B_k_cache": _B_in["k_cache"],
        "B_v_cache": _B_in["v_cache"],
        "B_wq": _B_in["wq"],
        "B_wo": _B_in["wo"],
    }

def reference(A_x, A_k_cache, A_v_cache, A_wq, A_wo, B_x, B_k_cache, B_v_cache, B_wq, B_wo):
    def _A_ref(x, k_cache, v_cache, wq, wo):
        B, Sq, D = x.shape
        H, Dh = 32, 128
        q = (lambda x, *d: x.permute(*d))((x @ wq).reshape(B, Sq, H, Dh), 0, 2, 1, 3)
        scores = torch.einsum("bhqd,bhkd->bhqk", q, k_cache) * (Dh ** -0.5)
        p = _softmax(scores, axis=-1)
        o = torch.einsum("bhqk,bhkd->bhqd", p, v_cache)
        return (lambda x, *d: x.permute(*d))(o, 0, 2, 1, 3).reshape(B, Sq, H * Dh) @ wo

    def _B_ref(x, k_cache, v_cache, wq, wo):
        B, Sq, D = x.shape
        Hq, Dh = 32, 128
        Hkv = k_cache.shape[1]
        rep = Hq // Hkv
        q = (lambda x, *d: x.permute(*d))((x @ wq).reshape(B, Sq, Hq, Dh), 0, 2, 1, 3)
        k = (lambda x, n, axis: torch.repeat_interleave(x, n, dim=axis))(k_cache, rep, axis=1)
        v = (lambda x, n, axis: torch.repeat_interleave(x, n, dim=axis))(v_cache, rep, axis=1)
        scores = torch.einsum("bhqd,bhkd->bhqk", q, k) * (Dh ** -0.5)
        p = _softmax(scores, axis=-1)
        o = torch.einsum("bhqk,bhkd->bhqd", p, v)
        return (lambda x, *d: x.permute(*d))(o, 0, 2, 1, 3).reshape(B, Sq, Hq * Dh) @ wo

    a = _A_ref(A_x, A_k_cache, A_v_cache, A_wq, A_wo)
    b = _B_ref(B_x, B_k_cache, B_v_cache, B_wq, B_wo)
    return torch.concatenate([a, b], axis=-1)
```

```asm
; @launch kernel=attn_kernel grid=(256,1,1) block=(256,1,1) lds=131072
; @launch kernel=oproj_kernel grid=(256,1,1) block=(256,1,1) lds=131072
.amdgcn_target "amdgcn-amd-amdhsa--gfx950"
.text
.globl attn_kernel
.p2align 8
.type attn_kernel,@function
attn_kernel:
    s_cmp_ge_u32 s2, 256
    s_cbranch_scc1 attn_done
    s_load_dwordx8 s[56:63], s[0:1], 0
    s_load_dwordx8 s[64:71], s[0:1], 40
    s_load_dwordx2 s[72:73], s[0:1], 96
    s_load_dwordx2 s[76:77], s[0:1], 32
    s_load_dwordx2 s[78:79], s[0:1], 72
    s_and_b32 s3, s2, 7
    s_lshr_b32 s4, s2, 3
    s_and_b32 s5, s4, 3
    s_lshl_b32 s5, s5, 3
    s_add_u32 s49, s3, s5
    s_lshr_b32 s50, s4, 2
    v_lshrrev_b32 v1, 6, v0
    v_and_b32 v0, 63, v0
    v_readfirstlane_b32 s44, v1
    s_mov_b32 s46, 0x3e0293ee
    s_lshl_b32 s45, s44, 12
    s_lshl_b32 s74, s44, 11
    v_lshrrev_b32 v40, 4, v0
    v_and_b32 v41, 15, v0
    s_lshl_b32 s3, s44, 4
    v_add_u32 v42, s3, v40
    v_add_u32 v43, 0, v40
    v_xor_b32 v43, v43, v41
    v_lshlrev_b32 v43, 4, v43
    v_lshl_add_u32 v2, v42, 8, v43
    v_add_u32 v43, 4, v40
    v_xor_b32 v43, v43, v41
    v_lshlrev_b32 v43, 4, v43
    v_lshl_add_u32 v3, v42, 8, v43
    v_add_u32 v43, 8, v40
    v_xor_b32 v43, v43, v41
    v_lshlrev_b32 v43, 4, v43
    v_lshl_add_u32 v4, v42, 8, v43
    v_add_u32 v43, 12, v40
    v_xor_b32 v43, v43, v41
    v_lshlrev_b32 v43, 4, v43
    v_lshl_add_u32 v5, v42, 8, v43
    v_lshlrev_b32 v43, 2, v40
    v_xor_b32 v43, v43, v41
    v_lshlrev_b32 v43, 4, v43
    v_lshl_add_u32 v6, v42, 8, v43
    s_lshl_b32 s3, s44, 3
    v_add_u32 v42, s3, v40
    v_lshl_add_u32 v7, v42, 13, v43
    v_lshrrev_b32 v42, 2, v0
    s_lshl_b32 s3, s44, 5
    v_add_u32 v42, s3, v42
    v_and_b32 v43, 3, v0
    v_xor_b32 v43, v43, v40
    v_lshlrev_b32 v43, 4, v43
    v_lshl_add_u32 v32, v42, 10, v43
    v_and_b32 v40, 31, v0
    v_lshrrev_b32 v41, 5, v0
    v_and_b32 v42, 0x13, v40
    v_and_b32 v43, 4, v40
    v_lshl_or_b32 v42, v43, 1, v42
    v_and_b32 v43, 8, v40
    v_lshrrev_b32 v43, 1, v43
    v_or_b32 v42, v42, v43
    v_and_b32 v44, 15, v42
    v_add_u32 v43, 0, v41
    v_xor_b32 v43, v43, v44
    v_lshlrev_b32 v43, 4, v43
    v_lshl_add_u32 v8, v42, 8, v43
    v_add_u32 v16, 0x10000, v8
    v_add_u32 v43, 2, v41
    v_xor_b32 v43, v43, v44
    v_lshlrev_b32 v43, 4, v43
    v_lshl_add_u32 v9, v42, 8, v43
    v_add_u32 v17, 0x10000, v9
    v_add_u32 v43, 4, v41
    v_xor_b32 v43, v43, v44
    v_lshlrev_b32 v43, 4, v43
    v_lshl_add_u32 v10, v42, 8, v43
    v_add_u32 v18, 0x10000, v10
    v_add_u32 v43, 6, v41
    v_xor_b32 v43, v43, v44
    v_lshlrev_b32 v43, 4, v43
    v_lshl_add_u32 v11, v42, 8, v43
    v_add_u32 v19, 0x10000, v11
    v_add_u32 v43, 8, v41
    v_xor_b32 v43, v43, v44
    v_lshlrev_b32 v43, 4, v43
    v_lshl_add_u32 v12, v42, 8, v43
    v_add_u32 v20, 0x10000, v12
    v_add_u32 v43, 10, v41
    v_xor_b32 v43, v43, v44
    v_lshlrev_b32 v43, 4, v43
    v_lshl_add_u32 v13, v42, 8, v43
    v_add_u32 v21, 0x10000, v13
    v_add_u32 v43, 12, v41
    v_xor_b32 v43, v43, v44
    v_lshlrev_b32 v43, 4, v43
    v_lshl_add_u32 v14, v42, 8, v43
    v_add_u32 v22, 0x10000, v14
    v_add_u32 v43, 14, v41
    v_xor_b32 v43, v43, v44
    v_lshlrev_b32 v43, 4, v43
    v_lshl_add_u32 v15, v42, 8, v43
    v_add_u32 v23, 0x10000, v15
    s_lshl_b32 s3, s44, 5
    v_add_u32 v43, s3, v40
    v_lshlrev_b32 v43, 6, v43
    v_add_u32 v43, 0x2000, v43
    v_bfe_u32 v44, v40, 2, 2
    v_add_u32 v45, 0, v41
    v_xor_b32 v45, v45, v44
    v_lshl_add_u32 v250, v45, 4, v43
    v_add_u32 v252, 0x10000, v250
    v_add_u32 v45, 2, v41
    v_xor_b32 v45, v45, v44
    v_lshl_add_u32 v251, v45, 4, v43
    v_add_u32 v253, 0x10000, v251
    v_lshlrev_b32 v33, 4, v0
    v_bfe_u32 v40, v0, 2, 2
    v_and_b32 v42, 3, v0
    v_bfe_u32 v43, v0, 4, 1
    v_and_b32 v44, 1, v42
    v_lshlrev_b32 v44, 1, v44
    v_lshrrev_b32 v45, 1, v42
    v_or_b32 v44, v44, v45
    v_lshl_add_u32 v45, v41, 3, v40
    v_lshlrev_b32 v45, 8, v45
    v_lshrrev_b32 v46, 1, v44
    v_lshl_add_u32 v46, v43, 1, v46
    v_lshl_add_u32 v45, v46, 4, v45
    v_and_b32 v46, 1, v44
    v_lshl_add_u32 v45, v46, 3, v45
    v_xor_b32 v46, 0, v40
    v_lshl_add_u32 v24, v46, 6, v45
    v_add_u32 v28, 0x10000, v24
    v_xor_b32 v46, 1, v40
    v_lshl_add_u32 v25, v46, 6, v45
    v_add_u32 v29, 0x10000, v25
    v_xor_b32 v46, 2, v40
    v_lshl_add_u32 v26, v46, 6, v45
    v_add_u32 v30, 0x10000, v26
    v_xor_b32 v46, 3, v40
    v_lshl_add_u32 v27, v46, 6, v45
    v_add_u32 v31, 0x10000, v27
    s_waitcnt lgkmcnt(0)
    s_add_u32 s92, s72, 0x6000000
    s_addc_u32 s93, s73, 0
    s_mov_b32 s94, 32768
    s_mov_b32 s95, 0x20000
    s_lshl_b32 s3, s2, 7
    v_mov_b32 v40, 0
    v_lshlrev_b32 v41, 2, v0
    v_add_u32 v41, s3, v41
    v_cmp_gt_u32 vcc, 32, v0
    s_and_saveexec_b64 s[4:5], vcc
    buffer_store_dword v40, v41, s[92:95], 0 offen
    s_mov_b64 exec, s[4:5]
    s_mov_b32 s48, 0
    s_mov_b32 s55, 0
    s_and_b32 s52, s55, 1
    s_lshl_b32 s52, s52, 3
    s_add_u32 s52, s52, s50
    s_lshr_b32 s51, s55, 1
    s_cmp_eq_u32 s51, 0
    s_cselect_b32 s24, s62, s70
    s_cselect_b32 s25, s63, s71
    s_lshl_b32 s53, s49, 8
    s_add_u32 s24, s24, s53
    s_addc_u32 s25, s25, 0
    s_sub_u32 s53, 4194304, s53
    s_cmp_lt_u32 s51, 2
    s_cselect_b32 s26, s53, 0
    s_mov_b32 s27, 0x20000
    s_cmp_eq_u32 s51, 0
    s_cselect_b32 s32, s56, s64
    s_cselect_b32 s33, s57, s65
    s_lshl_b32 s53, s52, 17
    s_add_u32 s32, s32, s53
    s_addc_u32 s33, s33, 0
    s_cmp_lt_u32 s51, 2
    s_cselect_b32 s34, 131072, 0
    s_mov_b32 s35, 0x20000
    s_and_b32 s52, s55, 1
    s_lshl_b32 s52, s52, 3
    s_add_u32 s52, s52, s50
    s_lshr_b32 s51, s55, 1
    s_lshl_b32 s53, s52, 5
    s_add_u32 s53, s53, s49
    s_lshl_b32 s53, s53, 17
    s_cmp_eq_u32 s51, 0
    s_cselect_b32 s16, s58, s66
    s_cselect_b32 s17, s59, s67
    s_add_u32 s16, s16, s53
    s_addc_u32 s17, s17, 0
    s_cmp_lt_u32 s51, 2
    s_cselect_b32 s18, 131072, 0
    s_mov_b32 s19, 0x20000
    s_cmp_eq_u32 s51, 0
    s_cselect_b32 s20, s60, s68
    s_cselect_b32 s21, s61, s69
    s_add_u32 s20, s20, s53
    s_addc_u32 s21, s21, 0
    s_cmp_lt_u32 s51, 2
    s_cselect_b32 s22, 131072, 0
    s_mov_b32 s23, 0x20000
    s_and_b32 s52, s55, 1
    s_lshl_b32 s52, s52, 3
    s_add_u32 s52, s52, s50
    s_lshr_b32 s51, s55, 1
    s_lshl_b32 s53, s52, 5
    s_add_u32 s53, s53, s49
    s_lshl_b32 s53, s53, 17
    s_cmp_eq_u32 s51, 0
    s_cselect_b32 s8, s58, s66
    s_cselect_b32 s9, s59, s67
    s_add_u32 s8, s8, s53
    s_addc_u32 s9, s9, 0
    s_cmp_lt_u32 s51, 2
    s_cselect_b32 s10, 131072, 0
    s_mov_b32 s11, 0x20000
    s_cmp_eq_u32 s51, 0
    s_cselect_b32 s12, s60, s68
    s_cselect_b32 s13, s61, s69
    s_add_u32 s12, s12, s53
    s_addc_u32 s13, s13, 0
    s_cmp_lt_u32 s51, 2
    s_cselect_b32 s14, 131072, 0
    s_mov_b32 s15, 0x20000
    s_and_b32 s52, s55, 1
    s_lshl_b32 s52, s52, 3
    s_add_u32 s52, s52, s50
    s_lshr_b32 s51, s55, 1
    s_lshl_b32 s53, s51, 6
    s_lshl_b32 s54, s52, 2
    s_add_u32 s53, s53, s54
    s_add_u32 s53, s53, s44
    s_lshl_b32 s53, s53, 8
    s_lshl_b32 s54, s49, 3
    s_add_u32 s53, s53, s54
    s_lshl_b32 s53, s53, 10
    s_add_u32 s40, s72, s53
    s_addc_u32 s41, s73, 0
    s_mov_b32 s42, 0
    s_mov_b32 s43, 0x20000
    s_mov_b32 s55, 1
    s_and_b32 s52, s55, 1
    s_lshl_b32 s52, s52, 3
    s_add_u32 s52, s52, s50
    s_lshr_b32 s51, s55, 1
    s_cmp_eq_u32 s51, 0
    s_cselect_b32 s28, s62, s70
    s_cselect_b32 s29, s63, s71
    s_lshl_b32 s53, s49, 8
    s_add_u32 s28, s28, s53
    s_addc_u32 s29, s29, 0
    s_sub_u32 s53, 4194304, s53
    s_cmp_lt_u32 s51, 2
    s_cselect_b32 s30, s53, 0
    s_mov_b32 s31, 0x20000
    s_cmp_eq_u32 s51, 0
    s_cselect_b32 s36, s56, s64
    s_cselect_b32 s37, s57, s65
    s_lshl_b32 s53, s52, 17
    s_add_u32 s36, s36, s53
    s_addc_u32 s37, s37, 0
    s_cmp_lt_u32 s51, 2
    s_cselect_b32 s38, 131072, 0
    s_mov_b32 s39, 0x20000
    s_add_u32 m0, s74, 0
    s_mov_b32 s47, 0
    buffer_load_dwordx4 v7, s[24:27], s47 offen lds
    s_add_u32 m0, s74, 1024
    s_mov_b32 s47, 32768
    buffer_load_dwordx4 v7, s[24:27], s47 offen lds
    s_add_u32 m0, s74, 8192
    s_mov_b32 s47, 0
    buffer_load_dwordx4 v32, s[32:35], s47 offen lds
    s_add_u32 m0, s74, 9216
    s_mov_b32 s47, 16384
    buffer_load_dwordx4 v32, s[32:35], s47 offen lds
    s_add_u32 m0, s74, 16384
    s_mov_b32 s47, 262144
    buffer_load_dwordx4 v7, s[24:27], s47 offen lds
    s_add_u32 m0, s74, 17408
    s_mov_b32 s47, 294912
    buffer_load_dwordx4 v7, s[24:27], s47 offen lds
    s_add_u32 m0, s74, 24576
    s_mov_b32 s47, 64
    buffer_load_dwordx4 v32, s[32:35], s47 offen lds
    s_add_u32 m0, s74, 25600
    s_mov_b32 s47, 16448
    buffer_load_dwordx4 v32, s[32:35], s47 offen lds
    s_add_u32 m0, s74, 32768
    s_mov_b32 s47, 524288
    buffer_load_dwordx4 v7, s[24:27], s47 offen lds
    s_add_u32 m0, s74, 33792
    s_mov_b32 s47, 557056
    buffer_load_dwordx4 v7, s[24:27], s47 offen lds
    s_add_u32 m0, s74, 40960
    s_mov_b32 s47, 128
    buffer_load_dwordx4 v32, s[32:35], s47 offen lds
    s_add_u32 m0, s74, 41984
    s_mov_b32 s47, 16512
    buffer_load_dwordx4 v32, s[32:35], s47 offen lds
    s_add_u32 m0, s74, 49152
    s_mov_b32 s47, 786432
    buffer_load_dwordx4 v7, s[24:27], s47 offen lds
    s_add_u32 m0, s74, 50176
    s_mov_b32 s47, 819200
    buffer_load_dwordx4 v7, s[24:27], s47 offen lds
    s_add_u32 m0, s74, 57344
    s_mov_b32 s47, 192
    buffer_load_dwordx4 v32, s[32:35], s47 offen lds
    s_add_u32 m0, s74, 58368
    s_mov_b32 s47, 16576
    buffer_load_dwordx4 v32, s[32:35], s47 offen lds
    s_add_u32 m0, s74, 65536
    s_mov_b32 s47, 1048576
    buffer_load_dwordx4 v7, s[24:27], s47 offen lds
    s_add_u32 m0, s74, 66560
    s_mov_b32 s47, 1081344
    buffer_load_dwordx4 v7, s[24:27], s47 offen lds
    s_add_u32 m0, s74, 73728
    s_mov_b32 s47, 256
    buffer_load_dwordx4 v32, s[32:35], s47 offen lds
    s_add_u32 m0, s74, 74752
    s_mov_b32 s47, 16640
    buffer_load_dwordx4 v32, s[32:35], s47 offen lds
    s_add_u32 m0, s74, 81920
    s_mov_b32 s47, 1310720
    buffer_load_dwordx4 v7, s[24:27], s47 offen lds
    s_add_u32 m0, s74, 82944
    s_mov_b32 s47, 1343488
    buffer_load_dwordx4 v7, s[24:27], s47 offen lds
    s_add_u32 m0, s74, 90112
    s_mov_b32 s47, 320
    buffer_load_dwordx4 v32, s[32:35], s47 offen lds
    s_add_u32 m0, s74, 91136
    s_mov_b32 s47, 16704
    buffer_load_dwordx4 v32, s[32:35], s47 offen lds
    s_add_u32 m0, s74, 98304
    s_mov_b32 s47, 1572864
    buffer_load_dwordx4 v7, s[24:27], s47 offen lds
    s_add_u32 m0, s74, 99328
    s_mov_b32 s47, 1605632
    buffer_load_dwordx4 v7, s[24:27], s47 offen lds
    s_add_u32 m0, s74, 106496
    s_mov_b32 s47, 384
    buffer_load_dwordx4 v32, s[32:35], s47 offen lds
    s_add_u32 m0, s74, 107520
    s_mov_b32 s47, 16768
    buffer_load_dwordx4 v32, s[32:35], s47 offen lds
    s_waitcnt vmcnt(24)
    s_barrier
    ds_read_b64_tr_b16 a[64:65], v24 offset:0
    ds_read_b64_tr_b16 a[66:67], v24 offset:1024
    ds_read_b128 a[96:99], v250 offset:0
    ds_read_b64_tr_b16 a[68:69], v25 offset:0
    ds_read_b64_tr_b16 a[70:71], v25 offset:1024
    ds_read_b64_tr_b16 a[72:73], v26 offset:0
    ds_read_b64_tr_b16 a[74:75], v26 offset:1024
    ds_read_b64_tr_b16 a[76:77], v27 offset:0
    ds_read_b64_tr_b16 a[78:79], v27 offset:1024
    ds_read_b64_tr_b16 a[80:81], v24 offset:4096
    ds_read_b64_tr_b16 a[82:83], v24 offset:5120
    ds_read_b128 a[100:103], v251 offset:0
    ds_read_b64_tr_b16 a[84:85], v25 offset:4096
    ds_read_b64_tr_b16 a[86:87], v25 offset:5120
    ds_read_b64_tr_b16 a[88:89], v26 offset:4096
    ds_read_b64_tr_b16 a[90:91], v26 offset:5120
    ds_read_b64_tr_b16 a[92:93], v27 offset:4096
    ds_read_b64_tr_b16 a[94:95], v27 offset:5120
    s_waitcnt vmcnt(20)
    s_barrier
    s_waitcnt lgkmcnt(15)
    v_mfma_f32_32x32x16_bf16 a[0:15], a[64:67], a[96:99], 0
    ds_read_b64_tr_b16 a[64:65], v24 offset:16384
    ds_read_b64_tr_b16 a[66:67], v24 offset:17408
    ds_read_b128 a[104:107], v250 offset:16384
    s_add_u32 m0, s74, 114688
    s_mov_b32 s47, 1835008
    buffer_load_dwordx4 v7, s[24:27], s47 offen lds
    s_waitcnt lgkmcnt(15)
    v_mfma_f32_32x32x16_bf16 a[16:31], a[68:71], a[96:99], 0
    ds_read_b64_tr_b16 a[68:69], v25 offset:16384
    ds_read_b64_tr_b16 a[70:71], v25 offset:17408
    s_waitcnt lgkmcnt(15)
    v_mfma_f32_32x32x16_bf16 a[32:47], a[72:75], a[96:99], 0
    ds_read_b64_tr_b16 a[72:73], v26 offset:16384
    ds_read_b64_tr_b16 a[74:75], v26 offset:17408
    s_add_u32 m0, s74, 115712
    s_mov_b32 s47, 1867776
    buffer_load_dwordx4 v7, s[24:27], s47 offen lds
    s_waitcnt lgkmcnt(15)
    v_mfma_f32_32x32x16_bf16 a[48:63], a[76:79], a[96:99], 0
    ds_read_b64_tr_b16 a[76:77], v27 offset:16384
    ds_read_b64_tr_b16 a[78:79], v27 offset:17408
    s_waitcnt lgkmcnt(15)
    v_mfma_f32_32x32x16_bf16 a[0:15], a[80:83], a[100:103], a[0:15]
    ds_read_b64_tr_b16 a[80:81], v24 offset:20480
    ds_read_b64_tr_b16 a[82:83], v24 offset:21504
    ds_read_b128 a[108:111], v251 offset:16384
    s_add_u32 m0, s74, 122880
    s_mov_b32 s47, 448
    buffer_load_dwordx4 v32, s[32:35], s47 offen lds
    s_waitcnt lgkmcnt(15)
    v_mfma_f32_32x32x16_bf16 a[16:31], a[84:87], a[100:103], a[16:31]
    ds_read_b64_tr_b16 a[84:85], v25 offset:20480
    ds_read_b64_tr_b16 a[86:87], v25 offset:21504
    s_waitcnt lgkmcnt(15)
    v_mfma_f32_32x32x16_bf16 a[32:47], a[88:91], a[100:103], a[32:47]
    ds_read_b64_tr_b16 a[88:89], v26 offset:20480
    ds_read_b64_tr_b16 a[90:91], v26 offset:21504
    s_add_u32 m0, s74, 123904
    s_mov_b32 s47, 16832
    buffer_load_dwordx4 v32, s[32:35], s47 offen lds
    s_waitcnt lgkmcnt(15)
    v_mfma_f32_32x32x16_bf16 a[48:63], a[92:95], a[100:103], a[48:63]
    ds_read_b64_tr_b16 a[92:93], v27 offset:20480
    ds_read_b64_tr_b16 a[94:95], v27 offset:21504
    s_waitcnt vmcnt(20)
    s_barrier
    s_waitcnt lgkmcnt(15)
    v_mfma_f32_32x32x16_bf16 a[0:15], a[64:67], a[104:107], a[0:15]
    ds_read_b64_tr_b16 a[64:65], v24 offset:32768
    ds_read_b64_tr_b16 a[66:67], v24 offset:33792
    ds_read_b128 a[96:99], v250 offset:32768
    s_add_u32 m0, s74, 0
    s_mov_b32 s47, 2097152
    buffer_load_dwordx4 v7, s[24:27], s47 offen lds
    s_waitcnt lgkmcnt(15)
    v_mfma_f32_32x32x16_bf16 a[16:31], a[68:71], a[104:107], a[16:31]
    ds_read_b64_tr_b16 a[68:69], v25 offset:32768
    ds_read_b64_tr_b16 a[70:71], v25 offset:33792
    s_waitcnt lgkmcnt(15)
    v_mfma_f32_32x32x16_bf16 a[32:47], a[72:75], a[104:107], a[32:47]
    ds_read_b64_tr_b16 a[72:73], v26 offset:32768
    ds_read_b64_tr_b16 a[74:75], v26 offset:33792
    s_add_u32 m0, s74, 1024
    s_mov_b32 s47, 2129920
    buffer_load_dwordx4 v7, s[24:27], s47 offen lds
    s_waitcnt lgkmcnt(15)
    v_mfma_f32_32x32x16_bf16 a[48:63], a[76:79], a[104:107], a[48:63]
    ds_read_b64_tr_b16 a[76:77], v27 offset:32768
    ds_read_b64_tr_b16 a[78:79], v27 offset:33792
    s_waitcnt lgkmcnt(15)
    v_mfma_f32_32x32x16_bf16 a[0:15], a[80:83], a[108:111], a[0:15]
    ds_read_b64_tr_b16 a[80:81], v24 offset:36864
    ds_read_b64_tr_b16 a[82:83], v24 offset:37888
    ds_read_b128 a[100:103], v251 offset:32768
    s_add_u32 m0, s74, 8192
    s_mov_b32 s47, 512
    buffer_load_dwordx4 v32, s[32:35], s47 offen lds
    s_waitcnt lgkmcnt(15)
    v_mfma_f32_32x32x16_bf16 a[16:31], a[84:87], a[108:111], a[16:31]
    ds_read_b64_tr_b16 a[84:85], v25 offset:36864
    ds_read_b64_tr_b16 a[86:87], v25 offset:37888
    s_waitcnt lgkmcnt(15)
    v_mfma_f32_32x32x16_bf16 a[32:47], a[88:91], a[108:111], a[32:47]
    ds_read_b64_tr_b16 a[88:89], v26 offset:36864
    ds_read_b64_tr_b16 a[90:91], v26 offset:37888
    s_add_u32 m0, s74, 9216
    s_mov_b32 s47, 16896
    buffer_load_dwordx4 v32, s[32:35], s47 offen lds
    s_waitcnt lgkmcnt(15)
    v_mfma_f32_32x32x16_bf16 a[48:63], a[92:95], a[108:111], a[48:63]
    ds_read_b64_tr_b16 a[92:93], v27 offset:36864
    ds_read_b64_tr_b16 a[94:95], v27 offset:37888
    s_waitcnt vmcnt(20)
    s_barrier
    s_waitcnt lgkmcnt(15)
    v_mfma_f32_32x32x16_bf16 a[0:15], a[64:67], a[96:99], a[0:15]
    ds_read_b64_tr_b16 a[64:65], v24 offset:49152
    ds_read_b64_tr_b16 a[66:67], v24 offset:50176
    ds_read_b128 a[104:107], v250 offset:49152
    s_add_u32 m0, s74, 16384
    s_mov_b32 s47, 2359296
    buffer_load_dwordx4 v7, s[24:27], s47 offen lds
    s_waitcnt lgkmcnt(15)
    v_mfma_f32_32x32x16_bf16 a[16:31], a[68:71], a[96:99], a[16:31]
    ds_read_b64_tr_b16 a[68:69], v25 offset:49152
    ds_read_b64_tr_b16 a[70:71], v25 offset:50176
    s_waitcnt lgkmcnt(15)
    v_mfma_f32_32x32x16_bf16 a[32:47], a[72:75], a[96:99], a[32:47]
    ds_read_b64_tr_b16 a[72:73], v26 offset:49152
    ds_read_b64_tr_b16 a[74:75], v26 offset:50176
    s_add_u32 m0, s74, 17408
    s_mov_b32 s47, 2392064
    buffer_load_dwordx4 v7, s[24:27], s47 offen lds
    s_waitcnt lgkmcnt(15)
    v_mfma_f32_32x32x16_bf16 a[48:63], a[76:79], a[96:99], a[48:63]
    ds_read_b64_tr_b16 a[76:77], v27 offset:49152
    ds_read_b64_tr_b16 a[78:79], v27 offset:50176
    s_waitcnt lgkmcnt(15)
    v_mfma_f32_32x32x16_bf16 a[0:15], a[80:83], a[100:103], a[0:15]
    ds_read_b64_tr_b16 a[80:81], v24 offset:53248
    ds_read_b64_tr_b16 a[82:83], v24 offset:54272
    ds_read_b128 a[108:111], v251 offset:49152
    s_add_u32 m0, s74, 24576
    s_mov_b32 s47, 576
    buffer_load_dwordx4 v32, s[32:35], s47 offen lds
    s_waitcnt lgkmcnt(15)
    v_mfma_f32_32x32x16_bf16 a[16:31], a[84:87], a[100:103], a[16:31]
    ds_read_b64_tr_b16 a[84:85], v25 offset:53248
    ds_read_b64_tr_b16 a[86:87], v25 offset:54272
    s_waitcnt lgkmcnt(15)
    v_mfma_f32_32x32x16_bf16 a[32:47], a[88:91], a[100:103], a[32:47]
    ds_read_b64_tr_b16 a[88:89], v26 offset:53248
    ds_read_b64_tr_b16 a[90:91], v26 offset:54272
    s_add_u32 m0, s74, 25600
    s_mov_b32 s47, 16960
    buffer_load_dwordx4 v32, s[32:35], s47 offen lds
    s_waitcnt lgkmcnt(15)
    v_mfma_f32_32x32x16_bf16 a[48:63], a[92:95], a[100:103], a[48:63]
    ds_read_b64_tr_b16 a[92:93], v27 offset:53248
    ds_read_b64_tr_b16 a[94:95], v27 offset:54272
    s_waitcnt vmcnt(20)
    s_barrier
    s_waitcnt lgkmcnt(15)
    v_mfma_f32_32x32x16_bf16 a[0:15], a[64:67], a[104:107], a[0:15]
    ds_read_b64_tr_b16 a[64:65], v28 offset:0
    ds_read_b64_tr_b16 a[66:67], v28 offset:1024
    ds_read_b128 a[96:99], v252 offset:0
    s_add_u32 m0, s74, 32768
    s_mov_b32 s47, 2621440
    buffer_load_dwordx4 v7, s[24:27], s47 offen lds
    s_waitcnt lgkmcnt(15)
    v_mfma_f32_32x32x16_bf16 a[16:31], a[68:71], a[104:107], a[16:31]
    ds_read_b64_tr_b16 a[68:69], v29 offset:0
    ds_read_b64_tr_b16 a[70:71], v29 offset:1024
    s_waitcnt lgkmcnt(15)
    v_mfma_f32_32x32x16_bf16 a[32:47], a[72:75], a[104:107], a[32:47]
    ds_read_b64_tr_b16 a[72:73], v30 offset:0
    ds_read_b64_tr_b16 a[74:75], v30 offset:1024
    s_add_u32 m0, s74, 33792
    s_mov_b32 s47, 2654208
    buffer_load_dwordx4 v7, s[24:27], s47 offen lds
    s_waitcnt lgkmcnt(15)
    v_mfma_f32_32x32x16_bf16 a[48:63], a[76:79], a[104:107], a[48:63]
    ds_read_b64_tr_b16 a[76:77], v31 offset:0
    ds_read_b64_tr_b16 a[78:79], v31 offset:1024
    s_waitcnt lgkmcnt(15)
    v_mfma_f32_32x32x16_bf16 a[0:15], a[80:83], a[108:111], a[0:15]
    ds_read_b64_tr_b16 a[80:81], v28 offset:4096
    ds_read_b64_tr_b16 a[82:83], v28 offset:5120
    ds_read_b128 a[100:103], v253 offset:0
    s_add_u32 m0, s74, 40960
    s_mov_b32 s47, 640
    buffer_load_dwordx4 v32, s[32:35], s47 offen lds
    s_waitcnt lgkmcnt(15)
    v_mfma_f32_32x32x16_bf16 a[16:31], a[84:87], a[108:111], a[16:31]
    ds_read_b64_tr_b16 a[84:85], v29 offset:4096
    ds_read_b64_tr_b16 a[86:87], v29 offset:5120
    s_waitcnt lgkmcnt(15)
    v_mfma_f32_32x32x16_bf16 a[32:47], a[88:91], a[108:111], a[32:47]
    ds_read_b64_tr_b16 a[88:89], v30 offset:4096
    ds_read_b64_tr_b16 a[90:91], v30 offset:5120
    s_add_u32 m0, s74, 41984
    s_mov_b32 s47, 17024
    buffer_load_dwordx4 v32, s[32:35], s47 offen lds
    s_waitcnt lgkmcnt(15)
    v_mfma_f32_32x32x16_bf16 a[48:63], a[92:95], a[108:111], a[48:63]
    ds_read_b64_tr_b16 a[92:93], v31 offset:4096
    ds_read_b64_tr_b16 a[94:95], v31 offset:5120
    s_waitcnt vmcnt(20)
    s_barrier
    s_waitcnt lgkmcnt(15)
    v_mfma_f32_32x32x16_bf16 a[0:15], a[64:67], a[96:99], a[0:15]
    ds_read_b64_tr_b16 a[64:65], v28 offset:16384
    ds_read_b64_tr_b16 a[66:67], v28 offset:17408
    ds_read_b128 a[104:107], v252 offset:16384
    s_add_u32 m0, s74, 49152
    s_mov_b32 s47, 2883584
    buffer_load_dwordx4 v7, s[24:27], s47 offen lds
    s_waitcnt lgkmcnt(15)
    v_mfma_f32_32x32x16_bf16 a[16:31], a[68:71], a[96:99], a[16:31]
    ds_read_b64_tr_b16 a[68:69], v29 offset:16384
    ds_read_b64_tr_b16 a[70:71], v29 offset:17408
    s_waitcnt lgkmcnt(15)
    v_mfma_f32_32x32x16_bf16 a[32:47], a[72:75], a[96:99], a[32:47]
    ds_read_b64_tr_b16 a[72:73], v30 offset:16384
    ds_read_b64_tr_b16 a[74:75], v30 offset:17408
    s_add_u32 m0, s74, 50176
    s_mov_b32 s47, 2916352
    buffer_load_dwordx4 v7, s[24:27], s47 offen lds
    s_waitcnt lgkmcnt(15)
    v_mfma_f32_32x32x16_bf16 a[48:63], a[76:79], a[96:99], a[48:63]
    ds_read_b64_tr_b16 a[76:77], v31 offset:16384
    ds_read_b64_tr_b16 a[78:79], v31 offset:17408
    s_waitcnt lgkmcnt(15)
    v_mfma_f32_32x32x16_bf16 a[0:15], a[80:83], a[100:103], a[0:15]
    ds_read_b64_tr_b16 a[80:81], v28 offset:20480
    ds_read_b64_tr_b16 a[82:83], v28 offset:21504
    ds_read_b128 a[108:111], v253 offset:16384
    s_add_u32 m0, s74, 57344
    s_mov_b32 s47, 704
    buffer_load_dwordx4 v32, s[32:35], s47 offen lds
    s_waitcnt lgkmcnt(15)
    v_mfma_f32_32x32x16_bf16 a[16:31], a[84:87], a[100:103], a[16:31]
    ds_read_b64_tr_b16 a[84:85], v29 offset:20480
    ds_read_b64_tr_b16 a[86:87], v29 offset:21504
    s_waitcnt lgkmcnt(15)
    v_mfma_f32_32x32x16_bf16 a[32:47], a[88:91], a[100:103], a[32:47]
    ds_read_b64_tr_b16 a[88:89], v30 offset:20480
    ds_read_b64_tr_b16 a[90:91], v30 offset:21504
    s_add_u32 m0, s74, 58368
    s_mov_b32 s47, 17088
    buffer_load_dwordx4 v32, s[32:35], s47 offen lds
    s_waitcnt lgkmcnt(15)
    v_mfma_f32_32x32x16_bf16 a[48:63], a[92:95], a[100:103], a[48:63]
    ds_read_b64_tr_b16 a[92:93], v31 offset:20480
    ds_read_b64_tr_b16 a[94:95], v31 offset:21504
    s_waitcnt vmcnt(20)
    s_barrier
    s_waitcnt lgkmcnt(15)
    v_mfma_f32_32x32x16_bf16 a[0:15], a[64:67], a[104:107], a[0:15]
    ds_read_b64_tr_b16 a[64:65], v28 offset:32768
    ds_read_b64_tr_b16 a[66:67], v28 offset:33792
    ds_read_b128 a[96:99], v252 offset:32768
    s_add_u32 m0, s74, 65536
    s_mov_b32 s47, 3145728
    buffer_load_dwordx4 v7, s[24:27], s47 offen lds
    s_waitcnt lgkmcnt(15)
    v_mfma_f32_32x32x16_bf16 a[16:31], a[68:71], a[104:107], a[16:31]
    ds_read_b64_tr_b16 a[68:69], v29 offset:32768
    ds_read_b64_tr_b16 a[70:71], v29 offset:33792
    s_waitcnt lgkmcnt(15)
    v_mfma_f32_32x32x16_bf16 a[32:47], a[72:75], a[104:107], a[32:47]
    ds_read_b64_tr_b16 a[72:73], v30 offset:32768
    ds_read_b64_tr_b16 a[74:75], v30 offset:33792
    s_add_u32 m0, s74, 66560
    s_mov_b32 s47, 3178496
    buffer_load_dwordx4 v7, s[24:27], s47 offen lds
    s_waitcnt lgkmcnt(15)
    v_mfma_f32_32x32x16_bf16 a[48:63], a[76:79], a[104:107], a[48:63]
    ds_read_b64_tr_b16 a[76:77], v31 offset:32768
    ds_read_b64_tr_b16 a[78:79], v31 offset:33792
    s_waitcnt lgkmcnt(15)
    v_mfma_f32_32x32x16_bf16 a[0:15], a[80:83], a[108:111], a[0:15]
    ds_read_b64_tr_b16 a[80:81], v28 offset:36864
    ds_read_b64_tr_b16 a[82:83], v28 offset:37888
    ds_read_b128 a[100:103], v253 offset:32768
    s_add_u32 m0, s74, 73728
    s_mov_b32 s47, 768
    buffer_load_dwordx4 v32, s[32:35], s47 offen lds
    s_waitcnt lgkmcnt(15)
    v_mfma_f32_32x32x16_bf16 a[16:31], a[84:87], a[108:111], a[16:31]
    ds_read_b64_tr_b16 a[84:85], v29 offset:36864
    ds_read_b64_tr_b16 a[86:87], v29 offset:37888
    s_waitcnt lgkmcnt(15)
    v_mfma_f32_32x32x16_bf16 a[32:47], a[88:91], a[108:111], a[32:47]
    ds_read_b64_tr_b16 a[88:89], v30 offset:36864
    ds_read_b64_tr_b16 a[90:91], v30 offset:37888
    s_add_u32 m0, s74, 74752
    s_mov_b32 s47, 17152
    buffer_load_dwordx4 v32, s[32:35], s47 offen lds
    s_waitcnt lgkmcnt(15)
    v_mfma_f32_32x32x16_bf16 a[48:63], a[92:95], a[108:111], a[48:63]
    ds_read_b64_tr_b16 a[92:93], v31 offset:36864
    ds_read_b64_tr_b16 a[94:95], v31 offset:37888
    s_waitcnt vmcnt(20)
    s_barrier
    s_waitcnt lgkmcnt(15)
    v_mfma_f32_32x32x16_bf16 a[0:15], a[64:67], a[96:99], a[0:15]
    ds_read_b64_tr_b16 a[64:65], v28 offset:49152
    ds_read_b64_tr_b16 a[66:67], v28 offset:50176
    ds_read_b128 a[104:107], v252 offset:49152
    s_add_u32 m0, s74, 81920
    s_mov_b32 s47, 3407872
    buffer_load_dwordx4 v7, s[24:27], s47 offen lds
    s_waitcnt lgkmcnt(15)
    v_mfma_f32_32x32x16_bf16 a[16:31], a[68:71], a[96:99], a[16:31]
    ds_read_b64_tr_b16 a[68:69], v29 offset:49152
    ds_read_b64_tr_b16 a[70:71], v29 offset:50176
    s_waitcnt lgkmcnt(15)
    v_mfma_f32_32x32x16_bf16 a[32:47], a[72:75], a[96:99], a[32:47]
    ds_read_b64_tr_b16 a[72:73], v30 offset:49152
    ds_read_b64_tr_b16 a[74:75], v30 offset:50176
    s_add_u32 m0, s74, 82944
    s_mov_b32 s47, 3440640
    buffer_load_dwordx4 v7, s[24:27], s47 offen lds
    s_waitcnt lgkmcnt(15)
    v_mfma_f32_32x32x16_bf16 a[48:63], a[76:79], a[96:99], a[48:63]
    ds_read_b64_tr_b16 a[76:77], v31 offset:49152
    ds_read_b64_tr_b16 a[78:79], v31 offset:50176
    s_waitcnt lgkmcnt(15)
    v_mfma_f32_32x32x16_bf16 a[0:15], a[80:83], a[100:103], a[0:15]
    ds_read_b64_tr_b16 a[80:81], v28 offset:53248
    ds_read_b64_tr_b16 a[82:83], v28 offset:54272
    ds_read_b128 a[108:111], v253 offset:49152
    s_add_u32 m0, s74, 90112
    s_mov_b32 s47, 832
    buffer_load_dwordx4 v32, s[32:35], s47 offen lds
    s_waitcnt lgkmcnt(15)
    v_mfma_f32_32x32x16_bf16 a[16:31], a[84:87], a[100:103], a[16:31]
    ds_read_b64_tr_b16 a[84:85], v29 offset:53248
    ds_read_b64_tr_b16 a[86:87], v29 offset:54272
    s_waitcnt lgkmcnt(15)
    v_mfma_f32_32x32x16_bf16 a[32:47], a[88:91], a[100:103], a[32:47]
    ds_read_b64_tr_b16 a[88:89], v30 offset:53248
    ds_read_b64_tr_b16 a[90:91], v30 offset:54272
    s_add_u32 m0, s74, 91136
    s_mov_b32 s47, 17216
    buffer_load_dwordx4 v32, s[32:35], s47 offen lds
    s_waitcnt lgkmcnt(15)
    v_mfma_f32_32x32x16_bf16 a[48:63], a[92:95], a[100:103], a[48:63]
    ds_read_b64_tr_b16 a[92:93], v31 offset:53248
    ds_read_b64_tr_b16 a[94:95], v31 offset:54272
    s_waitcnt vmcnt(20)
    s_barrier
    s_waitcnt lgkmcnt(15)
    v_mfma_f32_32x32x16_bf16 a[0:15], a[64:67], a[104:107], a[0:15]
    ds_read_b64_tr_b16 a[64:65], v24 offset:0
    ds_read_b64_tr_b16 a[66:67], v24 offset:1024
    ds_read_b128 a[96:99], v250 offset:0
    s_add_u32 m0, s74, 98304
    s_mov_b32 s47, 3670016
    buffer_load_dwordx4 v7, s[24:27], s47 offen lds
    s_waitcnt lgkmcnt(15)
    v_mfma_f32_32x32x16_bf16 a[16:31], a[68:71], a[104:107], a[16:31]
    ds_read_b64_tr_b16 a[68:69], v25 offset:0
    ds_read_b64_tr_b16 a[70:71], v25 offset:1024
    s_waitcnt lgkmcnt(15)
    v_mfma_f32_32x32x16_bf16 a[32:47], a[72:75], a[104:107], a[32:47]
    ds_read_b64_tr_b16 a[72:73], v26 offset:0
    ds_read_b64_tr_b16 a[74:75], v26 offset:1024
    s_add_u32 m0, s74, 99328
    s_mov_b32 s47, 3702784
    buffer_load_dwordx4 v7, s[24:27], s47 offen lds
    s_waitcnt lgkmcnt(15)
    v_mfma_f32_32x32x16_bf16 a[48:63], a[76:79], a[104:107], a[48:63]
    ds_read_b64_tr_b16 a[76:77], v27 offset:0
    ds_read_b64_tr_b16 a[78:79], v27 offset:1024
    s_waitcnt lgkmcnt(15)
    v_mfma_f32_32x32x16_bf16 a[0:15], a[80:83], a[108:111], a[0:15]
    ds_read_b64_tr_b16 a[80:81], v24 offset:4096
    ds_read_b64_tr_b16 a[82:83], v24 offset:5120
    ds_read_b128 a[100:103], v251 offset:0
    s_add_u32 m0, s74, 106496
    s_mov_b32 s47, 896
    buffer_load_dwordx4 v32, s[32:35], s47 offen lds
    s_waitcnt lgkmcnt(15)
    v_mfma_f32_32x32x16_bf16 a[16:31], a[84:87], a[108:111], a[16:31]
    ds_read_b64_tr_b16 a[84:85], v25 offset:4096
    ds_read_b64_tr_b16 a[86:87], v25 offset:5120
    s_waitcnt lgkmcnt(15)
    v_mfma_f32_32x32x16_bf16 a[32:47], a[88:91], a[108:111], a[32:47]
    ds_read_b64_tr_b16 a[88:89], v26 offset:4096
    ds_read_b64_tr_b16 a[90:91], v26 offset:5120
    s_add_u32 m0, s74, 107520
    s_mov_b32 s47, 17280
    buffer_load_dwordx4 v32, s[32:35], s47 offen lds
    s_waitcnt lgkmcnt(15)
    v_mfma_f32_32x32x16_bf16 a[48:63], a[92:95], a[108:111], a[48:63]
    ds_read_b64_tr_b16 a[92:93], v27 offset:4096
    ds_read_b64_tr_b16 a[94:95], v27 offset:5120
    s_waitcnt vmcnt(20)
    s_barrier
    s_waitcnt lgkmcnt(15)
    v_mfma_f32_32x32x16_bf16 a[0:15], a[64:67], a[96:99], a[0:15]
    ds_read_b64_tr_b16 a[64:65], v24 offset:16384
    ds_read_b64_tr_b16 a[66:67], v24 offset:17408
    ds_read_b128 a[104:107], v250 offset:16384
    s_add_u32 m0, s74, 114688
    s_mov_b32 s47, 3932160
    buffer_load_dwordx4 v7, s[24:27], s47 offen lds
    s_waitcnt lgkmcnt(15)
    v_mfma_f32_32x32x16_bf16 a[16:31], a[68:71], a[96:99], a[16:31]
    ds_read_b64_tr_b16 a[68:69], v25 offset:16384
    ds_read_b64_tr_b16 a[70:71], v25 offset:17408
    s_waitcnt lgkmcnt(15)
    v_mfma_f32_32x32x16_bf16 a[32:47], a[72:75], a[96:99], a[32:47]
    ds_read_b64_tr_b16 a[72:73], v26 offset:16384
    ds_read_b64_tr_b16 a[74:75], v26 offset:17408
    s_add_u32 m0, s74, 115712
    s_mov_b32 s47, 3964928
    buffer_load_dwordx4 v7, s[24:27], s47 offen lds
    s_waitcnt lgkmcnt(15)
    v_mfma_f32_32x32x16_bf16 a[48:63], a[76:79], a[96:99], a[48:63]
    ds_read_b64_tr_b16 a[76:77], v27 offset:16384
    ds_read_b64_tr_b16 a[78:79], v27 offset:17408
    s_waitcnt lgkmcnt(15)
    v_mfma_f32_32x32x16_bf16 a[0:15], a[80:83], a[100:103], a[0:15]
    ds_read_b64_tr_b16 a[80:81], v24 offset:20480
    ds_read_b64_tr_b16 a[82:83], v24 offset:21504
    ds_read_b128 a[108:111], v251 offset:16384
    s_add_u32 m0, s74, 122880
    s_mov_b32 s47, 960
    buffer_load_dwordx4 v32, s[32:35], s47 offen lds
    s_waitcnt lgkmcnt(15)
    v_mfma_f32_32x32x16_bf16 a[16:31], a[84:87], a[100:103], a[16:31]
    ds_read_b64_tr_b16 a[84:85], v25 offset:20480
    ds_read_b64_tr_b16 a[86:87], v25 offset:21504
    s_waitcnt lgkmcnt(15)
    v_mfma_f32_32x32x16_bf16 a[32:47], a[88:91], a[100:103], a[32:47]
    ds_read_b64_tr_b16 a[88:89], v26 offset:20480
    ds_read_b64_tr_b16 a[90:91], v26 offset:21504
    s_add_u32 m0, s74, 123904
    s_mov_b32 s47, 17344
    buffer_load_dwordx4 v32, s[32:35], s47 offen lds
    s_waitcnt lgkmcnt(15)
    v_mfma_f32_32x32x16_bf16 a[48:63], a[92:95], a[100:103], a[48:63]
    ds_read_b64_tr_b16 a[92:93], v27 offset:20480
    ds_read_b64_tr_b16 a[94:95], v27 offset:21504
    s_waitcnt vmcnt(20)
    s_barrier
    s_waitcnt lgkmcnt(15)
    v_mfma_f32_32x32x16_bf16 a[0:15], a[64:67], a[104:107], a[0:15]
    ds_read_b64_tr_b16 a[64:65], v24 offset:32768
    ds_read_b64_tr_b16 a[66:67], v24 offset:33792
    ds_read_b128 a[96:99], v250 offset:32768
    s_add_u32 m0, s45, 0
    s_mov_b32 s47, 0
    buffer_load_dwordx4 v2, s[16:19], s47 offen offset:0 nt lds
    s_waitcnt lgkmcnt(15)
    v_mfma_f32_32x32x16_bf16 a[16:31], a[68:71], a[104:107], a[16:31]
    ds_read_b64_tr_b16 a[68:69], v25 offset:32768
    ds_read_b64_tr_b16 a[70:71], v25 offset:33792
    s_waitcnt lgkmcnt(15)
    v_mfma_f32_32x32x16_bf16 a[32:47], a[72:75], a[104:107], a[32:47]
    ds_read_b64_tr_b16 a[72:73], v26 offset:32768
    ds_read_b64_tr_b16 a[74:75], v26 offset:33792
    s_add_u32 m0, s45, 0
    s_mov_b32 s47, 0
    buffer_load_dwordx4 v3, s[16:19], s47 offen offset:1024 nt lds
    s_waitcnt lgkmcnt(15)
    v_mfma_f32_32x32x16_bf16 a[48:63], a[76:79], a[104:107], a[48:63]
    ds_read_b64_tr_b16 a[76:77], v27 offset:32768
    ds_read_b64_tr_b16 a[78:79], v27 offset:33792
    s_waitcnt lgkmcnt(15)
    v_mfma_f32_32x32x16_bf16 a[0:15], a[80:83], a[108:111], a[0:15]
    ds_read_b64_tr_b16 a[80:81], v24 offset:36864
    ds_read_b64_tr_b16 a[82:83], v24 offset:37888
    ds_read_b128 a[100:103], v251 offset:32768
    s_add_u32 m0, s45, 0
    s_mov_b32 s47, 0
    buffer_load_dwordx4 v4, s[16:19], s47 offen offset:2048 nt lds
    s_waitcnt lgkmcnt(15)
    v_mfma_f32_32x32x16_bf16 a[16:31], a[84:87], a[108:111], a[16:31]
    ds_read_b64_tr_b16 a[84:85], v25 offset:36864
    ds_read_b64_tr_b16 a[86:87], v25 offset:37888
    s_waitcnt lgkmcnt(15)
    v_mfma_f32_32x32x16_bf16 a[32:47], a[88:91], a[108:111], a[32:47]
    ds_read_b64_tr_b16 a[88:89], v26 offset:36864
    ds_read_b64_tr_b16 a[90:91], v26 offset:37888
    s_add_u32 m0, s45, 0
    s_mov_b32 s47, 0
    buffer_load_dwordx4 v5, s[16:19], s47 offen offset:3072 nt lds
    s_waitcnt lgkmcnt(15)
    v_mfma_f32_32x32x16_bf16 a[48:63], a[92:95], a[108:111], a[48:63]
    ds_read_b64_tr_b16 a[92:93], v27 offset:36864
    ds_read_b64_tr_b16 a[94:95], v27 offset:37888
    s_waitcnt vmcnt(20)
    s_barrier
    s_waitcnt lgkmcnt(15)
    v_mfma_f32_32x32x16_bf16 a[0:15], a[64:67], a[96:99], a[0:15]
    ds_read_b64_tr_b16 a[64:65], v24 offset:49152
    ds_read_b64_tr_b16 a[66:67], v24 offset:50176
    ds_read_b128 a[104:107], v250 offset:49152
    s_add_u32 m0, s45, 16384
    s_mov_b32 s47, 16384
    buffer_load_dwordx4 v2, s[16:19], s47 offen offset:0 nt lds
    s_waitcnt lgkmcnt(15)
    v_mfma_f32_32x32x16_bf16 a[16:31], a[68:71], a[96:99], a[16:31]
    ds_read_b64_tr_b16 a[68:69], v25 offset:49152
    ds_read_b64_tr_b16 a[70:71], v25 offset:50176
    s_waitcnt lgkmcnt(15)
    v_mfma_f32_32x32x16_bf16 a[32:47], a[72:75], a[96:99], a[32:47]
    ds_read_b64_tr_b16 a[72:73], v26 offset:49152
    ds_read_b64_tr_b16 a[74:75], v26 offset:50176
    s_add_u32 m0, s45, 16384
    s_mov_b32 s47, 16384
    buffer_load_dwordx4 v3, s[16:19], s47 offen offset:1024 nt lds
    s_waitcnt lgkmcnt(15)
    v_mfma_f32_32x32x16_bf16 a[48:63], a[76:79], a[96:99], a[48:63]
    ds_read_b64_tr_b16 a[76:77], v27 offset:49152
    ds_read_b64_tr_b16 a[78:79], v27 offset:50176
    s_waitcnt lgkmcnt(15)
    v_mfma_f32_32x32x16_bf16 a[0:15], a[80:83], a[100:103], a[0:15]
    ds_read_b64_tr_b16 a[80:81], v24 offset:53248
    ds_read_b64_tr_b16 a[82:83], v24 offset:54272
    ds_read_b128 a[108:111], v251 offset:49152
    s_add_u32 m0, s45, 16384
    s_mov_b32 s47, 16384
    buffer_load_dwordx4 v4, s[16:19], s47 offen offset:2048 nt lds
    s_waitcnt lgkmcnt(15)
    v_mfma_f32_32x32x16_bf16 a[16:31], a[84:87], a[100:103], a[16:31]
    ds_read_b64_tr_b16 a[84:85], v25 offset:53248
    ds_read_b64_tr_b16 a[86:87], v25 offset:54272
    s_waitcnt lgkmcnt(15)
    v_mfma_f32_32x32x16_bf16 a[32:47], a[88:91], a[100:103], a[32:47]
    ds_read_b64_tr_b16 a[88:89], v26 offset:53248
    ds_read_b64_tr_b16 a[90:91], v26 offset:54272
    s_add_u32 m0, s45, 16384
    s_mov_b32 s47, 16384
    buffer_load_dwordx4 v5, s[16:19], s47 offen offset:3072 nt lds
    s_waitcnt lgkmcnt(15)
    v_mfma_f32_32x32x16_bf16 a[48:63], a[92:95], a[100:103], a[48:63]
    ds_read_b64_tr_b16 a[92:93], v27 offset:53248
    ds_read_b64_tr_b16 a[94:95], v27 offset:54272
    s_waitcnt vmcnt(20)
    s_barrier
    s_waitcnt lgkmcnt(15)
    v_mfma_f32_32x32x16_bf16 a[0:15], a[64:67], a[104:107], a[0:15]
    ds_read_b64_tr_b16 a[64:65], v28 offset:0
    ds_read_b64_tr_b16 a[66:67], v28 offset:1024
    ds_read_b128 a[96:99], v252 offset:0
    s_add_u32 m0, s74, 32768
    s_mov_b32 s47, 0
    buffer_load_dwordx4 v7, s[28:31], s47 offen lds
    s_waitcnt lgkmcnt(15)
    v_mfma_f32_32x32x16_bf16 a[16:31], a[68:71], a[104:107], a[16:31]
    ds_read_b64_tr_b16 a[68:69], v29 offset:0
    ds_read_b64_tr_b16 a[70:71], v29 offset:1024
    s_waitcnt lgkmcnt(15)
    v_mfma_f32_32x32x16_bf16 a[32:47], a[72:75], a[104:107], a[32:47]
    ds_read_b64_tr_b16 a[72:73], v30 offset:0
    ds_read_b64_tr_b16 a[74:75], v30 offset:1024
    s_add_u32 m0, s74, 33792
    s_mov_b32 s47, 32768
    buffer_load_dwordx4 v7, s[28:31], s47 offen lds
    s_waitcnt lgkmcnt(15)
    v_mfma_f32_32x32x16_bf16 a[48:63], a[76:79], a[104:107], a[48:63]
    ds_read_b64_tr_b16 a[76:77], v31 offset:0
    ds_read_b64_tr_b16 a[78:79], v31 offset:1024
    s_waitcnt lgkmcnt(15)
    v_mfma_f32_32x32x16_bf16 a[0:15], a[80:83], a[108:111], a[0:15]
    ds_read_b64_tr_b16 a[80:81], v28 offset:4096
    ds_read_b64_tr_b16 a[82:83], v28 offset:5120
    ds_read_b128 a[100:103], v253 offset:0
    s_add_u32 m0, s74, 40960
    s_mov_b32 s47, 0
    buffer_load_dwordx4 v32, s[36:39], s47 offen lds
    s_waitcnt lgkmcnt(15)
    v_mfma_f32_32x32x16_bf16 a[16:31], a[84:87], a[108:111], a[16:31]
    ds_read_b64_tr_b16 a[84:85], v29 offset:4096
    ds_read_b64_tr_b16 a[86:87], v29 offset:5120
    s_waitcnt lgkmcnt(15)
    v_mfma_f32_32x32x16_bf16 a[32:47], a[88:91], a[108:111], a[32:47]
    ds_read_b64_tr_b16 a[88:89], v30 offset:4096
    ds_read_b64_tr_b16 a[90:91], v30 offset:5120
    s_add_u32 m0, s74, 41984
    s_mov_b32 s47, 16384
    buffer_load_dwordx4 v32, s[36:39], s47 offen lds
    s_waitcnt lgkmcnt(15)
    v_mfma_f32_32x32x16_bf16 a[48:63], a[92:95], a[108:111], a[48:63]
    ds_read_b64_tr_b16 a[92:93], v31 offset:4096
    ds_read_b64_tr_b16 a[94:95], v31 offset:5120
    s_waitcnt vmcnt(20)
    s_barrier
    s_waitcnt lgkmcnt(15)
    v_mfma_f32_32x32x16_bf16 a[0:15], a[64:67], a[96:99], a[0:15]
    ds_read_b64_tr_b16 a[64:65], v28 offset:16384
    ds_read_b64_tr_b16 a[66:67], v28 offset:17408
    ds_read_b128 a[104:107], v252 offset:16384
    s_add_u32 m0, s74, 49152
    s_mov_b32 s47, 262144
    buffer_load_dwordx4 v7, s[28:31], s47 offen lds
    s_waitcnt lgkmcnt(15)
    v_mfma_f32_32x32x16_bf16 a[16:31], a[68:71], a[96:99], a[16:31]
    ds_read_b64_tr_b16 a[68:69], v29 offset:16384
    ds_read_b64_tr_b16 a[70:71], v29 offset:17408
    s_waitcnt lgkmcnt(15)
    v_mfma_f32_32x32x16_bf16 a[32:47], a[72:75], a[96:99], a[32:47]
    ds_read_b64_tr_b16 a[72:73], v30 offset:16384
    ds_read_b64_tr_b16 a[74:75], v30 offset:17408
    s_add_u32 m0, s74, 50176
    s_mov_b32 s47, 294912
    buffer_load_dwordx4 v7, s[28:31], s47 offen lds
    s_waitcnt lgkmcnt(15)
    v_mfma_f32_32x32x16_bf16 a[48:63], a[76:79], a[96:99], a[48:63]
    ds_read_b64_tr_b16 a[76:77], v31 offset:16384
    ds_read_b64_tr_b16 a[78:79], v31 offset:17408
    s_waitcnt lgkmcnt(15)
    v_mfma_f32_32x32x16_bf16 a[0:15], a[80:83], a[100:103], a[0:15]
    ds_read_b64_tr_b16 a[80:81], v28 offset:20480
    ds_read_b64_tr_b16 a[82:83], v28 offset:21504
    ds_read_b128 a[108:111], v253 offset:16384
    s_add_u32 m0, s74, 57344
    s_mov_b32 s47, 64
    buffer_load_dwordx4 v32, s[36:39], s47 offen lds
    s_waitcnt lgkmcnt(15)
    v_mfma_f32_32x32x16_bf16 a[16:31], a[84:87], a[100:103], a[16:31]
    ds_read_b64_tr_b16 a[84:85], v29 offset:20480
    ds_read_b64_tr_b16 a[86:87], v29 offset:21504
    s_waitcnt lgkmcnt(15)
    v_mfma_f32_32x32x16_bf16 a[32:47], a[88:91], a[100:103], a[32:47]
    ds_read_b64_tr_b16 a[88:89], v30 offset:20480
    ds_read_b64_tr_b16 a[90:91], v30 offset:21504
    s_add_u32 m0, s74, 58368
    s_mov_b32 s47, 16448
    buffer_load_dwordx4 v32, s[36:39], s47 offen lds
    s_waitcnt lgkmcnt(15)
    v_mfma_f32_32x32x16_bf16 a[48:63], a[92:95], a[100:103], a[48:63]
    ds_read_b64_tr_b16 a[92:93], v31 offset:20480
    ds_read_b64_tr_b16 a[94:95], v31 offset:21504
    s_waitcnt vmcnt(20)
    s_barrier
    s_waitcnt lgkmcnt(15)
    v_mfma_f32_32x32x16_bf16 a[0:15], a[64:67], a[104:107], a[0:15]
    ds_read_b64_tr_b16 a[64:65], v28 offset:32768
    ds_read_b64_tr_b16 a[66:67], v28 offset:33792
    ds_read_b128 a[96:99], v252 offset:32768
    s_add_u32 m0, s74, 65536
    s_mov_b32 s47, 524288
    buffer_load_dwordx4 v7, s[28:31], s47 offen lds
    s_waitcnt lgkmcnt(15)
    v_mfma_f32_32x32x16_bf16 a[16:31], a[68:71], a[104:107], a[16:31]
    ds_read_b64_tr_b16 a[68:69], v29 offset:32768
    ds_read_b64_tr_b16 a[70:71], v29 offset:33792
    s_waitcnt lgkmcnt(15)
    v_mfma_f32_32x32x16_bf16 a[32:47], a[72:75], a[104:107], a[32:47]
    ds_read_b64_tr_b16 a[72:73], v30 offset:32768
    ds_read_b64_tr_b16 a[74:75], v30 offset:33792
    s_add_u32 m0, s74, 66560
    s_mov_b32 s47, 557056
    buffer_load_dwordx4 v7, s[28:31], s47 offen lds
    s_waitcnt lgkmcnt(15)
    v_mfma_f32_32x32x16_bf16 a[48:63], a[76:79], a[104:107], a[48:63]
    ds_read_b64_tr_b16 a[76:77], v31 offset:32768
    ds_read_b64_tr_b16 a[78:79], v31 offset:33792
    s_waitcnt lgkmcnt(15)
    v_mfma_f32_32x32x16_bf16 a[0:15], a[80:83], a[108:111], a[0:15]
    ds_read_b64_tr_b16 a[80:81], v28 offset:36864
    ds_read_b64_tr_b16 a[82:83], v28 offset:37888
    ds_read_b128 a[100:103], v253 offset:32768
    s_add_u32 m0, s74, 73728
    s_mov_b32 s47, 128
    buffer_load_dwordx4 v32, s[36:39], s47 offen lds
    s_waitcnt lgkmcnt(15)
    v_mfma_f32_32x32x16_bf16 a[16:31], a[84:87], a[108:111], a[16:31]
    ds_read_b64_tr_b16 a[84:85], v29 offset:36864
    ds_read_b64_tr_b16 a[86:87], v29 offset:37888
    s_waitcnt lgkmcnt(15)
    v_mfma_f32_32x32x16_bf16 a[32:47], a[88:91], a[108:111], a[32:47]
    ds_read_b64_tr_b16 a[88:89], v30 offset:36864
    ds_read_b64_tr_b16 a[90:91], v30 offset:37888
    s_add_u32 m0, s74, 74752
    s_mov_b32 s47, 16512
    buffer_load_dwordx4 v32, s[36:39], s47 offen lds
    s_waitcnt lgkmcnt(15)
    v_mfma_f32_32x32x16_bf16 a[48:63], a[92:95], a[108:111], a[48:63]
    ds_read_b64_tr_b16 a[92:93], v31 offset:36864
    ds_read_b64_tr_b16 a[94:95], v31 offset:37888
    s_waitcnt vmcnt(20)
    s_barrier
    s_waitcnt lgkmcnt(15)
    v_mfma_f32_32x32x16_bf16 a[0:15], a[64:67], a[96:99], a[0:15]
    ds_read_b64_tr_b16 a[64:65], v28 offset:49152
    ds_read_b64_tr_b16 a[66:67], v28 offset:50176
    ds_read_b128 a[104:107], v252 offset:49152
    s_add_u32 m0, s74, 81920
    s_mov_b32 s47, 786432
    buffer_load_dwordx4 v7, s[28:31], s47 offen lds
    s_waitcnt lgkmcnt(15)
    v_mfma_f32_32x32x16_bf16 a[16:31], a[68:71], a[96:99], a[16:31]
    ds_read_b64_tr_b16 a[68:69], v29 offset:49152
    ds_read_b64_tr_b16 a[70:71], v29 offset:50176
    s_waitcnt lgkmcnt(15)
    v_mfma_f32_32x32x16_bf16 a[32:47], a[72:75], a[96:99], a[32:47]
    ds_read_b64_tr_b16 a[72:73], v30 offset:49152
    ds_read_b64_tr_b16 a[74:75], v30 offset:50176
    s_add_u32 m0, s74, 82944
    s_mov_b32 s47, 819200
    buffer_load_dwordx4 v7, s[28:31], s47 offen lds
    s_waitcnt lgkmcnt(15)
    v_mfma_f32_32x32x16_bf16 a[48:63], a[76:79], a[96:99], a[48:63]
    ds_read_b64_tr_b16 a[76:77], v31 offset:49152
    ds_read_b64_tr_b16 a[78:79], v31 offset:50176
    s_waitcnt lgkmcnt(15)
    v_mfma_f32_32x32x16_bf16 a[0:15], a[80:83], a[100:103], a[0:15]
    ds_read_b64_tr_b16 a[80:81], v28 offset:53248
    ds_read_b64_tr_b16 a[82:83], v28 offset:54272
    ds_read_b128 a[108:111], v253 offset:49152
    s_add_u32 m0, s74, 90112
    s_mov_b32 s47, 192
    buffer_load_dwordx4 v32, s[36:39], s47 offen lds
    s_waitcnt lgkmcnt(15)
    v_mfma_f32_32x32x16_bf16 a[16:31], a[84:87], a[100:103], a[16:31]
    ds_read_b64_tr_b16 a[84:85], v29 offset:53248
    ds_read_b64_tr_b16 a[86:87], v29 offset:54272
    s_waitcnt lgkmcnt(15)
    v_mfma_f32_32x32x16_bf16 a[32:47], a[88:91], a[100:103], a[32:47]
    ds_read_b64_tr_b16 a[88:89], v30 offset:53248
    ds_read_b64_tr_b16 a[90:91], v30 offset:54272
    s_add_u32 m0, s74, 91136
    s_mov_b32 s47, 16576
    buffer_load_dwordx4 v32, s[36:39], s47 offen lds
    s_waitcnt lgkmcnt(15)
    v_mfma_f32_32x32x16_bf16 a[48:63], a[92:95], a[100:103], a[48:63]
    ds_read_b64_tr_b16 a[92:93], v31 offset:53248
    ds_read_b64_tr_b16 a[94:95], v31 offset:54272
    s_waitcnt vmcnt(20)
    s_barrier
    s_waitcnt lgkmcnt(15)
    v_mfma_f32_32x32x16_bf16 a[0:15], a[64:67], a[104:107], a[0:15]
    ds_read_b128 a[64:67], v8 offset:0
    s_add_u32 m0, s45, 98304
    s_mov_b32 s47, 0
    buffer_load_dwordx4 v6, s[20:23], s47 offen offset:0 nt lds
    s_waitcnt lgkmcnt(14)
    v_mfma_f32_32x32x16_bf16 a[16:31], a[68:71], a[104:107], a[16:31]
    ds_read_b128 a[68:71], v9 offset:0
    s_waitcnt lgkmcnt(13)
    v_mfma_f32_32x32x16_bf16 a[32:47], a[72:75], a[104:107], a[32:47]
    ds_read_b128 a[72:75], v10 offset:0
    s_add_u32 m0, s45, 98304
    s_mov_b32 s47, 0
    buffer_load_dwordx4 v6, s[20:23], s47 offen offset:1024 nt lds
    s_waitcnt lgkmcnt(12)
    v_mfma_f32_32x32x16_bf16 a[48:63], a[76:79], a[104:107], a[48:63]
    ds_read_b128 a[76:79], v11 offset:0
    s_waitcnt lgkmcnt(10)
    v_mfma_f32_32x32x16_bf16 a[0:15], a[80:83], a[108:111], a[0:15]
    ds_read_b128 a[80:83], v12 offset:0
    s_add_u32 m0, s45, 98304
    s_mov_b32 s47, 0
    buffer_load_dwordx4 v6, s[20:23], s47 offen offset:2048 nt lds
    s_waitcnt lgkmcnt(9)
    v_mfma_f32_32x32x16_bf16 a[16:31], a[84:87], a[108:111], a[16:31]
    ds_read_b128 a[84:87], v13 offset:0
    s_waitcnt lgkmcnt(8)
    v_mfma_f32_32x32x16_bf16 a[32:47], a[88:91], a[108:111], a[32:47]
    ds_read_b128 a[88:91], v14 offset:0
    s_add_u32 m0, s45, 98304
    s_mov_b32 s47, 0
    buffer_load_dwordx4 v6, s[20:23], s47 offen offset:3072 nt lds
    s_waitcnt lgkmcnt(7)
    v_mfma_f32_32x32x16_bf16 a[48:63], a[92:95], a[108:111], a[48:63]
    ds_read_b128 a[92:95], v15 offset:0
    s_nop 15
    v_accvgpr_read_b32 v240, a0
    v_accvgpr_read_b32 v241, a1
    v_accvgpr_read_b32 v242, a2
    v_accvgpr_read_b32 v243, a3
    v_accvgpr_read_b32 v244, a4
    v_accvgpr_read_b32 v245, a5
    v_accvgpr_read_b32 v246, a6
    v_accvgpr_read_b32 v247, a7
    v_cvt_pk_bf16_f32 v208, v240, v241
    v_cvt_pk_bf16_f32 v209, v242, v243
    v_cvt_pk_bf16_f32 v210, v244, v245
    v_cvt_pk_bf16_f32 v211, v246, v247
    v_accvgpr_read_b32 v240, a8
    v_accvgpr_read_b32 v241, a9
    v_accvgpr_read_b32 v242, a10
    v_accvgpr_read_b32 v243, a11
    v_accvgpr_read_b32 v244, a12
    v_accvgpr_read_b32 v245, a13
    v_accvgpr_read_b32 v246, a14
    v_accvgpr_read_b32 v247, a15
    v_cvt_pk_bf16_f32 v212, v240, v241
    v_cvt_pk_bf16_f32 v213, v242, v243
    v_cvt_pk_bf16_f32 v214, v244, v245
    v_cvt_pk_bf16_f32 v215, v246, v247
    v_accvgpr_read_b32 v240, a16
    v_accvgpr_read_b32 v241, a17
    v_accvgpr_read_b32 v242, a18
    v_accvgpr_read_b32 v243, a19
    v_accvgpr_read_b32 v244, a20
    v_accvgpr_read_b32 v245, a21
    v_accvgpr_read_b32 v246, a22
    v_accvgpr_read_b32 v247, a23
    v_cvt_pk_bf16_f32 v216, v240, v241
    v_cvt_pk_bf16_f32 v217, v242, v243
    v_cvt_pk_bf16_f32 v218, v244, v245
    v_cvt_pk_bf16_f32 v219, v246, v247
    v_accvgpr_read_b32 v240, a24
    v_accvgpr_read_b32 v241, a25
    v_accvgpr_read_b32 v242, a26
    v_accvgpr_read_b32 v243, a27
    v_accvgpr_read_b32 v244, a28
    v_accvgpr_read_b32 v245, a29
    v_accvgpr_read_b32 v246, a30
    v_accvgpr_read_b32 v247, a31
    v_cvt_pk_bf16_f32 v220, v240, v241
    v_cvt_pk_bf16_f32 v221, v242, v243
    v_cvt_pk_bf16_f32 v222, v244, v245
    v_cvt_pk_bf16_f32 v223, v246, v247
    v_accvgpr_read_b32 v240, a32
    v_accvgpr_read_b32 v241, a33
    v_accvgpr_read_b32 v242, a34
    v_accvgpr_read_b32 v243, a35
    v_accvgpr_read_b32 v244, a36
    v_accvgpr_read_b32 v245, a37
    v_accvgpr_read_b32 v246, a38
    v_accvgpr_read_b32 v247, a39
    v_cvt_pk_bf16_f32 v224, v240, v241
    v_cvt_pk_bf16_f32 v225, v242, v243
    v_cvt_pk_bf16_f32 v226, v244, v245
    v_cvt_pk_bf16_f32 v227, v246, v247
    v_accvgpr_read_b32 v240, a40
    v_accvgpr_read_b32 v241, a41
    v_accvgpr_read_b32 v242, a42
    v_accvgpr_read_b32 v243, a43
    v_accvgpr_read_b32 v244, a44
    v_accvgpr_read_b32 v245, a45
    v_accvgpr_read_b32 v246, a46
    v_accvgpr_read_b32 v247, a47
    v_cvt_pk_bf16_f32 v228, v240, v241
    v_cvt_pk_bf16_f32 v229, v242, v243
    v_cvt_pk_bf16_f32 v230, v244, v245
    v_cvt_pk_bf16_f32 v231, v246, v247
    v_accvgpr_read_b32 v240, a48
    v_accvgpr_read_b32 v241, a49
    v_accvgpr_read_b32 v242, a50
    v_accvgpr_read_b32 v243, a51
    v_accvgpr_read_b32 v244, a52
    v_accvgpr_read_b32 v245, a53
    v_accvgpr_read_b32 v246, a54
    v_accvgpr_read_b32 v247, a55
    v_cvt_pk_bf16_f32 v232, v240, v241
    v_cvt_pk_bf16_f32 v233, v242, v243
    v_cvt_pk_bf16_f32 v234, v244, v245
    v_cvt_pk_bf16_f32 v235, v246, v247
    v_accvgpr_read_b32 v240, a56
    v_accvgpr_read_b32 v241, a57
    v_accvgpr_read_b32 v242, a58
    v_accvgpr_read_b32 v243, a59
    v_accvgpr_read_b32 v244, a60
    v_accvgpr_read_b32 v245, a61
    v_accvgpr_read_b32 v246, a62
    v_accvgpr_read_b32 v247, a63
    v_cvt_pk_bf16_f32 v236, v240, v241
    v_cvt_pk_bf16_f32 v237, v242, v243
    v_cvt_pk_bf16_f32 v238, v244, v245
    v_cvt_pk_bf16_f32 v239, v246, v247
    s_nop 1
    s_mov_b32 s55, 1
    s_and_b32 s52, s55, 1
    s_lshl_b32 s52, s52, 3
    s_add_u32 s52, s52, s50
    s_lshr_b32 s51, s55, 1
    s_lshl_b32 s53, s52, 5
    s_add_u32 s53, s53, s49
    s_lshl_b32 s53, s53, 17
    s_cmp_eq_u32 s51, 0
    s_cselect_b32 s16, s58, s66
    s_cselect_b32 s17, s59, s67
    s_add_u32 s16, s16, s53
    s_addc_u32 s17, s17, 0
    s_cmp_lt_u32 s51, 2
    s_cselect_b32 s18, 131072, 0
    s_mov_b32 s19, 0x20000
    s_cmp_eq_u32 s51, 0
    s_cselect_b32 s20, s60, s68
    s_cselect_b32 s21, s61, s69
    s_add_u32 s20, s20, s53
    s_addc_u32 s21, s21, 0
    s_cmp_lt_u32 s51, 2
    s_cselect_b32 s22, 131072, 0
    s_mov_b32 s23, 0x20000
    s_mov_b64 s[24:25], s[28:29]
    s_mov_b64 s[26:27], s[30:31]
    s_mov_b64 s[32:33], s[36:37]
    s_mov_b64 s[34:35], s[38:39]
    s_mov_b32 s55, 2
    s_and_b32 s52, s55, 1
    s_lshl_b32 s52, s52, 3
    s_add_u32 s52, s52, s50
    s_lshr_b32 s51, s55, 1
    s_cmp_eq_u32 s51, 0
    s_cselect_b32 s28, s62, s70
    s_cselect_b32 s29, s63, s71
    s_lshl_b32 s53, s49, 8
    s_add_u32 s28, s28, s53
    s_addc_u32 s29, s29, 0
    s_sub_u32 s53, 4194304, s53
    s_cmp_lt_u32 s51, 2
    s_cselect_b32 s30, s53, 0
    s_mov_b32 s31, 0x20000
    s_cmp_eq_u32 s51, 0
    s_cselect_b32 s36, s56, s64
    s_cselect_b32 s37, s57, s65
    s_lshl_b32 s53, s52, 17
    s_add_u32 s36, s36, s53
    s_addc_u32 s37, s37, 0
    s_cmp_lt_u32 s51, 2
    s_cselect_b32 s38, 131072, 0
    s_mov_b32 s39, 0x20000
attn_loop:
    s_cmp_lg_u32 s48, 3
    s_cbranch_scc1 attn_nowarm
    s_cmp_lt_u32 s2, 128
    s_cselect_b32 s92, s76, s78
    s_cselect_b32 s93, s77, s79
    s_mov_b32 s94, 4194304
    s_mov_b32 s95, 0x20000
    s_and_b32 s3, s2, 127
    s_lshl_b32 s3, s3, 15
    s_lshl_b32 s4, s44, 13
    s_add_u32 s3, s3, s4
    s_add_u32 s4, s3, 4096
    buffer_load_dwordx4 a[112:115], v33, s[92:95], s3 offen offset:0
    buffer_load_dwordx4 a[112:115], v33, s[92:95], s3 offen offset:1024
    buffer_load_dwordx4 a[112:115], v33, s[92:95], s3 offen offset:2048
    buffer_load_dwordx4 a[112:115], v33, s[92:95], s3 offen offset:3072
    buffer_load_dwordx4 a[112:115], v33, s[92:95], s4 offen offset:0
    buffer_load_dwordx4 a[112:115], v33, s[92:95], s4 offen offset:1024
    buffer_load_dwordx4 a[112:115], v33, s[92:95], s4 offen offset:2048
    buffer_load_dwordx4 a[112:115], v33, s[92:95], s4 offen offset:3072
attn_nowarm:
    s_waitcnt vmcnt(20)
    s_barrier
    s_waitcnt lgkmcnt(7)
    v_mfma_f32_32x32x16_bf16 v[112:127], a[64:67], v[208:211], 0
    ds_read_b128 a[64:67], v8 offset:8192
    s_nop 7
    s_nop 7
    v_mov_b32 v248, v35
    s_nop 1
    s_waitcnt lgkmcnt(7)
    v_mfma_f32_32x32x16_bf16 v[112:127], a[68:71], v[212:215], v[112:127]
    ds_read_b128 a[68:71], v9 offset:8192
    s_add_u32 m0, s45, 114688
    s_mov_b32 s47, 16384
    buffer_load_dwordx4 v6, s[12:15], s47 offen offset:0 nt lds
    v_permlane32_swap_b32 v35, v248
    s_nop 1
    v_add_f32 v35, v35, v248
    v_rcp_f32 v35, v35
    s_waitcnt lgkmcnt(7)
    v_mfma_f32_32x32x16_bf16 v[112:127], a[72:75], v[216:219], v[112:127]
    ds_read_b128 a[72:75], v10 offset:8192
    s_nop 0
    v_mul_f32 v48, v35, v48
    v_mul_f32 v49, v35, v49
    v_mul_f32 v50, v35, v50
    s_waitcnt lgkmcnt(7)
    v_mfma_f32_32x32x16_bf16 v[112:127], a[76:79], v[220:223], v[112:127]
    ds_read_b128 a[76:79], v11 offset:8192
    v_mul_f32 v51, v35, v51
    v_mul_f32 v52, v35, v52
    v_mul_f32 v53, v35, v53
    v_mul_f32 v54, v35, v54
    s_waitcnt lgkmcnt(7)
    v_mfma_f32_32x32x16_bf16 v[112:127], a[80:83], v[224:227], v[112:127]
    ds_read_b128 a[80:83], v12 offset:8192
    v_mul_f32 v55, v35, v55
    v_cvt_pk_bf16_f32 v176, v48, v49
    v_cvt_pk_bf16_f32 v177, v50, v51
    v_cvt_pk_bf16_f32 v178, v52, v53
    s_waitcnt lgkmcnt(7)
    v_mfma_f32_32x32x16_bf16 v[112:127], a[84:87], v[228:231], v[112:127]
    ds_read_b128 a[84:87], v13 offset:8192
    s_add_u32 m0, s45, 114688
    s_mov_b32 s47, 16384
    buffer_load_dwordx4 v6, s[12:15], s47 offen offset:1024 nt lds
    v_cvt_pk_bf16_f32 v179, v54, v55
    buffer_store_dwordx4 v[176:179], v33, s[40:43], 0 offen offset:0 sc1
    v_mul_f32 v56, v35, v56
    v_mul_f32 v57, v35, v57
    s_waitcnt lgkmcnt(7)
    v_mfma_f32_32x32x16_bf16 v[112:127], a[88:91], v[232:235], v[112:127]
    ds_read_b128 a[88:91], v14 offset:8192
    v_mul_f32 v58, v35, v58
    v_mul_f32 v59, v35, v59
    v_mul_f32 v60, v35, v60
    v_mul_f32 v61, v35, v61
    s_waitcnt lgkmcnt(7)
    v_mfma_f32_32x32x16_bf16 v[112:127], a[92:95], v[236:239], v[112:127]
    ds_read_b128 a[92:95], v15 offset:8192
    v_mul_f32 v62, v35, v62
    v_mul_f32 v63, v35, v63
    v_cvt_pk_bf16_f32 v180, v56, v57
    v_cvt_pk_bf16_f32 v181, v58, v59
    s_waitcnt lgkmcnt(7)
    v_mfma_f32_32x32x16_bf16 v[128:143], a[64:67], v[208:211], 0
    ds_read_b128 a[64:67], v8 offset:16384
    v_cvt_pk_bf16_f32 v182, v60, v61
    v_cvt_pk_bf16_f32 v183, v62, v63
    buffer_store_dwordx4 v[180:183], v33, s[40:43], 0 offen offset:1024 sc1
    v_mul_f32 v64, v35, v64
    s_waitcnt lgkmcnt(7)
    v_mfma_f32_32x32x16_bf16 v[128:143], a[68:71], v[212:215], v[128:143]
    ds_read_b128 a[68:71], v9 offset:16384
    s_add_u32 m0, s45, 114688
    s_mov_b32 s47, 16384
    buffer_load_dwordx4 v6, s[12:15], s47 offen offset:2048 nt lds
    v_mul_f32 v65, v35, v65
    v_mul_f32 v66, v35, v66
    v_mul_f32 v67, v35, v67
    v_mul_f32 v68, v35, v68
    s_waitcnt lgkmcnt(7)
    v_mfma_f32_32x32x16_bf16 v[128:143], a[72:75], v[216:219], v[128:143]
    ds_read_b128 a[72:75], v10 offset:16384
    v_mul_f32 v69, v35, v69
    v_mul_f32 v70, v35, v70
    v_mul_f32 v71, v35, v71
    v_cvt_pk_bf16_f32 v184, v64, v65
    s_waitcnt lgkmcnt(7)
    v_mfma_f32_32x32x16_bf16 v[128:143], a[76:79], v[220:223], v[128:143]
    ds_read_b128 a[76:79], v11 offset:16384
    v_cvt_pk_bf16_f32 v185, v66, v67
    v_cvt_pk_bf16_f32 v186, v68, v69
    v_cvt_pk_bf16_f32 v187, v70, v71
    buffer_store_dwordx4 v[184:187], v33, s[40:43], 0 offen offset:2048 sc1
    s_waitcnt lgkmcnt(7)
    v_mfma_f32_32x32x16_bf16 v[128:143], a[80:83], v[224:227], v[128:143]
    ds_read_b128 a[80:83], v12 offset:16384
    v_mul_f32 v72, v35, v72
    v_mul_f32 v73, v35, v73
    v_mul_f32 v74, v35, v74
    v_mul_f32 v75, v35, v75
    s_waitcnt lgkmcnt(7)
    v_mfma_f32_32x32x16_bf16 v[128:143], a[84:87], v[228:231], v[128:143]
    ds_read_b128 a[84:87], v13 offset:16384
    s_add_u32 m0, s45, 114688
    s_mov_b32 s47, 16384
    buffer_load_dwordx4 v6, s[12:15], s47 offen offset:3072 nt lds
    v_mul_f32 v76, v35, v76
    v_mul_f32 v77, v35, v77
    v_mul_f32 v78, v35, v78
    v_mul_f32 v79, v35, v79
    s_waitcnt lgkmcnt(7)
    v_mfma_f32_32x32x16_bf16 v[128:143], a[88:91], v[232:235], v[128:143]
    ds_read_b128 a[88:91], v14 offset:16384
    v_cvt_pk_bf16_f32 v188, v72, v73
    v_cvt_pk_bf16_f32 v189, v74, v75
    v_cvt_pk_bf16_f32 v190, v76, v77
    v_cvt_pk_bf16_f32 v191, v78, v79
    s_waitcnt lgkmcnt(7)
    v_mfma_f32_32x32x16_bf16 v[128:143], a[92:95], v[236:239], v[128:143]
    ds_read_b128 a[92:95], v15 offset:16384
    buffer_store_dwordx4 v[188:191], v33, s[40:43], 0 offen offset:3072 sc1
    v_mul_f32 v80, v35, v80
    v_mul_f32 v81, v35, v81
    v_mul_f32 v82, v35, v82
    s_waitcnt vmcnt(24)
    s_barrier
    s_waitcnt lgkmcnt(7)
    v_mfma_f32_32x32x16_bf16 v[144:159], a[64:67], v[208:211], 0
    ds_read_b128 a[64:67], v8 offset:24576
    v_mul_f32 v83, v35, v83
    v_mul_f32 v84, v35, v84
    v_mul_f32 v85, v35, v85
    v_mul_f32 v86, v35, v86
    v_mul_f32 v87, v35, v87
    s_waitcnt lgkmcnt(7)
    v_mfma_f32_32x32x16_bf16 v[144:159], a[68:71], v[212:215], v[144:159]
    ds_read_b128 a[68:71], v9 offset:24576
    s_add_u32 m0, s45, 0
    s_mov_b32 s47, 32768
    buffer_load_dwordx4 v2, s[8:11], s47 offen offset:0 nt lds
    v_cvt_pk_bf16_f32 v192, v80, v81
    v_cvt_pk_bf16_f32 v193, v82, v83
    v_cvt_pk_bf16_f32 v194, v84, v85
    v_cvt_pk_bf16_f32 v195, v86, v87
    s_mov_b32 s51, 4096
    s_waitcnt lgkmcnt(7)
    v_mfma_f32_32x32x16_bf16 v[144:159], a[72:75], v[216:219], v[144:159]
    ds_read_b128 a[72:75], v10 offset:24576
    buffer_store_dwordx4 v[192:195], v33, s[40:43], s51 offen offset:0 sc1
    v_mul_f32 v88, v35, v88
    v_mul_f32 v89, v35, v89
    v_mul_f32 v90, v35, v90
    v_mul_f32 v91, v35, v91
    s_waitcnt lgkmcnt(7)
    v_mfma_f32_32x32x16_bf16 v[144:159], a[76:79], v[220:223], v[144:159]
    ds_read_b128 a[76:79], v11 offset:24576
    v_mul_f32 v92, v35, v92
    v_mul_f32 v93, v35, v93
    v_mul_f32 v94, v35, v94
    v_mul_f32 v95, v35, v95
    v_cvt_pk_bf16_f32 v196, v88, v89
    s_waitcnt lgkmcnt(7)
    v_mfma_f32_32x32x16_bf16 v[144:159], a[80:83], v[224:227], v[144:159]
    ds_read_b128 a[80:83], v12 offset:24576
    v_cvt_pk_bf16_f32 v197, v90, v91
    v_cvt_pk_bf16_f32 v198, v92, v93
    v_cvt_pk_bf16_f32 v199, v94, v95
    buffer_store_dwordx4 v[196:199], v33, s[40:43], s51 offen offset:1024 sc1
    v_mul_f32 v96, v35, v96
    s_waitcnt lgkmcnt(7)
    v_mfma_f32_32x32x16_bf16 v[144:159], a[84:87], v[228:231], v[144:159]
    ds_read_b128 a[84:87], v13 offset:24576
    s_add_u32 m0, s45, 0
    s_mov_b32 s47, 32768
    buffer_load_dwordx4 v3, s[8:11], s47 offen offset:1024 nt lds
    v_mul_f32 v97, v35, v97
    v_mul_f32 v98, v35, v98
    v_mul_f32 v99, v35, v99
    v_mul_f32 v100, v35, v100
    v_mul_f32 v101, v35, v101
    s_waitcnt lgkmcnt(7)
    v_mfma_f32_32x32x16_bf16 v[144:159], a[88:91], v[232:235], v[144:159]
    ds_read_b128 a[88:91], v14 offset:24576
    v_mul_f32 v102, v35, v102
    v_mul_f32 v103, v35, v103
    v_cvt_pk_bf16_f32 v200, v96, v97
    v_cvt_pk_bf16_f32 v201, v98, v99
    v_cvt_pk_bf16_f32 v202, v100, v101
    s_waitcnt lgkmcnt(7)
    v_mfma_f32_32x32x16_bf16 v[144:159], a[92:95], v[236:239], v[144:159]
    ds_read_b128 a[92:95], v15 offset:24576
    v_cvt_pk_bf16_f32 v203, v102, v103
    buffer_store_dwordx4 v[200:203], v33, s[40:43], s51 offen offset:2048 sc1
    v_mul_f32 v104, v35, v104
    v_mul_f32 v105, v35, v105
    v_mul_f32 v106, v35, v106
    s_waitcnt lgkmcnt(7)
    v_mfma_f32_32x32x16_bf16 v[160:175], a[64:67], v[208:211], 0
    ds_read_b64_tr_b16 a[64:65], v24 offset:32768
    ds_read_b64_tr_b16 a[66:67], v24 offset:33792
    ds_read_b128 a[96:99], v250 offset:32768
    v_mul_f32 v107, v35, v107
    v_mul_f32 v108, v35, v108
    v_mul_f32 v109, v35, v109
    v_mul_f32 v110, v35, v110
    v_mul_f32 v111, v35, v111
    s_waitcnt lgkmcnt(9)
    v_mfma_f32_32x32x16_bf16 v[160:175], a[68:71], v[212:215], v[160:175]
    ds_read_b64_tr_b16 a[68:69], v25 offset:32768
    ds_read_b64_tr_b16 a[70:71], v25 offset:33792
    s_add_u32 m0, s45, 0
    s_mov_b32 s47, 32768
    buffer_load_dwordx4 v4, s[8:11], s47 offen offset:2048 nt lds
    v_cvt_pk_bf16_f32 v204, v104, v105
    v_cvt_pk_bf16_f32 v205, v106, v107
    v_cvt_pk_bf16_f32 v206, v108, v109
    v_cvt_pk_bf16_f32 v207, v110, v111
    buffer_store_dwordx4 v[204:207], v33, s[40:43], s51 offen offset:3072 sc1
    s_waitcnt lgkmcnt(10)
    v_mfma_f32_32x32x16_bf16 v[160:175], a[72:75], v[216:219], v[160:175]
    ds_read_b64_tr_b16 a[72:73], v26 offset:32768
    ds_read_b64_tr_b16 a[74:75], v26 offset:33792
    s_nop 3
    v_max3_f32 v40, v112, v113, v114
    v_max3_f32 v41, v128, v129, v130
    v_max3_f32 v40, v40, v115, v116
    v_max3_f32 v41, v41, v131, v132
    s_waitcnt lgkmcnt(11)
    v_mfma_f32_32x32x16_bf16 v[160:175], a[76:79], v[220:223], v[160:175]
    ds_read_b64_tr_b16 a[76:77], v27 offset:32768
    ds_read_b64_tr_b16 a[78:79], v27 offset:33792
    v_max3_f32 v40, v40, v117, v118
    v_max3_f32 v41, v41, v133, v134
    v_max3_f32 v40, v40, v119, v120
    v_max3_f32 v41, v41, v135, v136
    v_max3_f32 v40, v40, v121, v122
    s_waitcnt lgkmcnt(12)
    v_mfma_f32_32x32x16_bf16 v[160:175], a[80:83], v[224:227], v[160:175]
    ds_read_b64_tr_b16 a[80:81], v24 offset:36864
    ds_read_b64_tr_b16 a[82:83], v24 offset:37888
    ds_read_b128 a[100:103], v251 offset:32768
    v_max3_f32 v41, v41, v137, v138
    v_max3_f32 v40, v40, v123, v124
    v_max3_f32 v41, v41, v139, v140
    v_max3_f32 v40, v40, v125, v126
    v_max3_f32 v41, v41, v141, v142
    s_waitcnt lgkmcnt(14)
    v_mfma_f32_32x32x16_bf16 v[160:175], a[84:87], v[228:231], v[160:175]
    ds_read_b64_tr_b16 a[84:85], v25 offset:36864
    ds_read_b64_tr_b16 a[86:87], v25 offset:37888
    s_add_u32 m0, s45, 0
    s_mov_b32 s47, 32768
    buffer_load_dwordx4 v5, s[8:11], s47 offen offset:3072 nt lds
    v_max_f32 v40, v40, v127
    v_max_f32 v41, v41, v143
    s_waitcnt lgkmcnt(15)
    v_mfma_f32_32x32x16_bf16 v[160:175], a[88:91], v[232:235], v[160:175]
    ds_read_b64_tr_b16 a[88:89], v26 offset:36864
    ds_read_b64_tr_b16 a[90:91], v26 offset:37888
    s_waitcnt lgkmcnt(15)
    v_mfma_f32_32x32x16_bf16 v[160:175], a[92:95], v[236:239], v[160:175]
    ds_read_b64_tr_b16 a[92:93], v27 offset:36864
    ds_read_b64_tr_b16 a[94:95], v27 offset:37888
    s_nop 1
    s_waitcnt vmcnt(28)
    s_barrier
    s_waitcnt lgkmcnt(15)
    v_mfma_f32_32x32x16_bf16 a[0:15], a[64:67], a[96:99], 0
    ds_read_b64_tr_b16 a[64:65], v24 offset:49152
    ds_read_b64_tr_b16 a[66:67], v24 offset:50176
    ds_read_b128 a[104:107], v250 offset:49152
    s_add_u32 m0, s45, 16384
    s_mov_b32 s47, 49152
    buffer_load_dwordx4 v2, s[8:11], s47 offen offset:0 nt lds
    s_nop 7
    v_max3_f32 v42, v144, v145, v146
    v_max3_f32 v43, v160, v161, v162
    v_max3_f32 v42, v42, v147, v148
    s_waitcnt lgkmcnt(15)
    v_mfma_f32_32x32x16_bf16 a[16:31], a[68:71], a[96:99], 0
    ds_read_b64_tr_b16 a[68:69], v25 offset:49152
    ds_read_b64_tr_b16 a[70:71], v25 offset:50176
    v_max3_f32 v43, v43, v163, v164
    v_max3_f32 v42, v42, v149, v150
    v_max3_f32 v43, v43, v165, v166
    v_max3_f32 v42, v42, v151, v152
    s_waitcnt lgkmcnt(15)
    v_mfma_f32_32x32x16_bf16 a[32:47], a[72:75], a[96:99], 0
    ds_read_b64_tr_b16 a[72:73], v26 offset:49152
    ds_read_b64_tr_b16 a[74:75], v26 offset:50176
    s_add_u32 m0, s45, 16384
    s_mov_b32 s47, 49152
    buffer_load_dwordx4 v3, s[8:11], s47 offen offset:1024 nt lds
    v_max3_f32 v43, v43, v167, v168
    v_max3_f32 v42, v42, v153, v154
    v_max3_f32 v43, v43, v169, v170
    v_max3_f32 v42, v42, v155, v156
    s_waitcnt lgkmcnt(15)
    v_mfma_f32_32x32x16_bf16 a[48:63], a[76:79], a[96:99], 0
    ds_read_b64_tr_b16 a[76:77], v27 offset:49152
    ds_read_b64_tr_b16 a[78:79], v27 offset:50176
    v_max3_f32 v43, v43, v171, v172
    v_max3_f32 v42, v42, v157, v158
    v_max3_f32 v43, v43, v173, v174
    v_max_f32 v42, v42, v159
    s_waitcnt lgkmcnt(15)
    v_mfma_f32_32x32x16_bf16 a[0:15], a[80:83], a[100:103], a[0:15]
    ds_read_b64_tr_b16 a[80:81], v24 offset:53248
    ds_read_b64_tr_b16 a[82:83], v24 offset:54272
    ds_read_b128 a[108:111], v251 offset:49152
    s_add_u32 m0, s45, 16384
    s_mov_b32 s47, 49152
    buffer_load_dwordx4 v4, s[8:11], s47 offen offset:2048 nt lds
    v_max_f32 v43, v43, v175
    v_max3_f32 v40, v40, v41, v42
    v_max_f32 v40, v40, v43
    v_mov_b32 v41, v40
    s_waitcnt lgkmcnt(15)
    v_mfma_f32_32x32x16_bf16 a[16:31], a[84:87], a[100:103], a[16:31]
    ds_read_b64_tr_b16 a[84:85], v25 offset:53248
    ds_read_b64_tr_b16 a[86:87], v25 offset:54272
    s_nop 1
    v_permlane32_swap_b32 v40, v41
    s_nop 1
    v_max_f32 v34, v40, v41
    s_waitcnt lgkmcnt(15)
    v_mfma_f32_32x32x16_bf16 a[32:47], a[88:91], a[100:103], a[32:47]
    ds_read_b64_tr_b16 a[88:89], v26 offset:53248
    ds_read_b64_tr_b16 a[90:91], v26 offset:54272
    s_add_u32 m0, s45, 16384
    s_mov_b32 s47, 49152
    buffer_load_dwordx4 v5, s[8:11], s47 offen offset:3072 nt lds
    v_mul_f32 v44, s46, v34
    v_fma_f32 v112, v112, s46, -v44
    v_fma_f32 v113, v113, s46, -v44
    v_fma_f32 v114, v114, s46, -v44
    s_waitcnt lgkmcnt(15)
    v_mfma_f32_32x32x16_bf16 a[48:63], a[92:95], a[100:103], a[48:63]
    ds_read_b64_tr_b16 a[92:93], v27 offset:53248
    ds_read_b64_tr_b16 a[94:95], v27 offset:54272
    v_fma_f32 v115, v115, s46, -v44
    v_exp_f32 v112, v112
    v_exp_f32 v113, v113
    v_exp_f32 v114, v114
    s_waitcnt vmcnt(28)
    s_barrier
    s_waitcnt lgkmcnt(15)
    v_mfma_f32_32x32x16_bf16 a[0:15], a[64:67], a[104:107], a[0:15]
    ds_read_b64_tr_b16 a[64:65], v28 offset:0
    ds_read_b64_tr_b16 a[66:67], v28 offset:1024
    ds_read_b128 a[96:99], v252 offset:0
    s_add_u32 m0, s74, 32768
    s_mov_b32 s47, 1048576
    buffer_load_dwordx4 v7, s[24:27], s47 offen lds
    v_exp_f32 v115, v115
    v_fma_f32 v116, v116, s46, -v44
    v_fma_f32 v117, v117, s46, -v44
    v_fma_f32 v118, v118, s46, -v44
    s_waitcnt lgkmcnt(15)
    v_mfma_f32_32x32x16_bf16 a[16:31], a[68:71], a[104:107], a[16:31]
    ds_read_b64_tr_b16 a[68:69], v29 offset:0
    ds_read_b64_tr_b16 a[70:71], v29 offset:1024
    v_fma_f32 v119, v119, s46, -v44
    v_exp_f32 v116, v116
    v_exp_f32 v117, v117
    v_exp_f32 v118, v118
    s_waitcnt lgkmcnt(15)
    v_mfma_f32_32x32x16_bf16 a[32:47], a[72:75], a[104:107], a[32:47]
    ds_read_b64_tr_b16 a[72:73], v30 offset:0
    ds_read_b64_tr_b16 a[74:75], v30 offset:1024
    s_add_u32 m0, s74, 33792
    s_mov_b32 s47, 1081344
    buffer_load_dwordx4 v7, s[24:27], s47 offen lds
    v_exp_f32 v119, v119
    v_cvt_pk_bf16_f32 v176, v112, v113
    v_cvt_pk_bf16_f32 v177, v114, v115
    v_fma_f32 v120, v120, s46, -v44
    s_waitcnt lgkmcnt(15)
    v_mfma_f32_32x32x16_bf16 a[48:63], a[76:79], a[104:107], a[48:63]
    ds_read_b64_tr_b16 a[76:77], v31 offset:0
    ds_read_b64_tr_b16 a[78:79], v31 offset:1024
    v_fma_f32 v121, v121, s46, -v44
    v_fma_f32 v122, v122, s46, -v44
    v_fma_f32 v123, v123, s46, -v44
    v_exp_f32 v120, v120
    s_waitcnt lgkmcnt(15)
    v_mfma_f32_32x32x16_bf16 a[0:15], a[80:83], a[108:111], a[0:15]
    ds_read_b64_tr_b16 a[80:81], v28 offset:4096
    ds_read_b64_tr_b16 a[82:83], v28 offset:5120
    ds_read_b128 a[100:103], v253 offset:0
    s_add_u32 m0, s74, 40960
    s_mov_b32 s47, 256
    buffer_load_dwordx4 v32, s[32:35], s47 offen lds
    v_exp_f32 v121, v121
    v_exp_f32 v122, v122
    v_exp_f32 v123, v123
    v_cvt_pk_bf16_f32 v178, v116, v117
    s_waitcnt lgkmcnt(15)
    v_mfma_f32_32x32x16_bf16 a[16:31], a[84:87], a[108:111], a[16:31]
    ds_read_b64_tr_b16 a[84:85], v29 offset:4096
    ds_read_b64_tr_b16 a[86:87], v29 offset:5120
    v_cvt_pk_bf16_f32 v179, v118, v119
    v_fma_f32 v124, v124, s46, -v44
    v_fma_f32 v125, v125, s46, -v44
    v_fma_f32 v126, v126, s46, -v44
    s_waitcnt lgkmcnt(15)
    v_mfma_f32_32x32x16_bf16 a[32:47], a[88:91], a[108:111], a[32:47]
    ds_read_b64_tr_b16 a[88:89], v30 offset:4096
    ds_read_b64_tr_b16 a[90:91], v30 offset:5120
    s_add_u32 m0, s74, 41984
    s_mov_b32 s47, 16640
    buffer_load_dwordx4 v32, s[32:35], s47 offen lds
    v_fma_f32 v127, v127, s46, -v44
    v_exp_f32 v124, v124
    v_exp_f32 v125, v125
    v_exp_f32 v126, v126
    s_waitcnt lgkmcnt(15)
    v_mfma_f32_32x32x16_bf16 a[48:63], a[92:95], a[108:111], a[48:63]
    ds_read_b64_tr_b16 a[92:93], v31 offset:4096
    ds_read_b64_tr_b16 a[94:95], v31 offset:5120
    v_exp_f32 v127, v127
    v_cvt_pk_bf16_f32 v180, v120, v121
    v_cvt_pk_bf16_f32 v181, v122, v123
    v_fma_f32 v128, v128, s46, -v44
    s_waitcnt vmcnt(28)
    s_barrier
    s_waitcnt lgkmcnt(15)
    v_mfma_f32_32x32x16_bf16 a[0:15], a[64:67], a[96:99], a[0:15]
    ds_read_b64_tr_b16 a[64:65], v28 offset:16384
    ds_read_b64_tr_b16 a[66:67], v28 offset:17408
    ds_read_b128 a[104:107], v252 offset:16384
    s_add_u32 m0, s74, 49152
    s_mov_b32 s47, 1310720
    buffer_load_dwordx4 v7, s[24:27], s47 offen lds
    v_fma_f32 v129, v129, s46, -v44
    v_fma_f32 v130, v130, s46, -v44
    v_fma_f32 v131, v131, s46, -v44
    v_exp_f32 v128, v128
    s_waitcnt lgkmcnt(15)
    v_mfma_f32_32x32x16_bf16 a[16:31], a[68:71], a[96:99], a[16:31]
    ds_read_b64_tr_b16 a[68:69], v29 offset:16384
    ds_read_b64_tr_b16 a[70:71], v29 offset:17408
    v_exp_f32 v129, v129
    v_exp_f32 v130, v130
    v_exp_f32 v131, v131
    v_cvt_pk_bf16_f32 v182, v124, v125
    s_waitcnt lgkmcnt(15)
    v_mfma_f32_32x32x16_bf16 a[32:47], a[72:75], a[96:99], a[32:47]
    ds_read_b64_tr_b16 a[72:73], v30 offset:16384
    ds_read_b64_tr_b16 a[74:75], v30 offset:17408
    s_add_u32 m0, s74, 50176
    s_mov_b32 s47, 1343488
    buffer_load_dwordx4 v7, s[24:27], s47 offen lds
    v_cvt_pk_bf16_f32 v183, v126, v127
    v_fma_f32 v132, v132, s46, -v44
    v_fma_f32 v133, v133, s46, -v44
    v_fma_f32 v134, v134, s46, -v44
    s_waitcnt lgkmcnt(15)
    v_mfma_f32_32x32x16_bf16 a[48:63], a[76:79], a[96:99], a[48:63]
    ds_read_b64_tr_b16 a[76:77], v31 offset:16384
    ds_read_b64_tr_b16 a[78:79], v31 offset:17408
    v_fma_f32 v135, v135, s46, -v44
    v_exp_f32 v132, v132
    v_exp_f32 v133, v133
    v_exp_f32 v134, v134
    s_waitcnt lgkmcnt(15)
    v_mfma_f32_32x32x16_bf16 a[0:15], a[80:83], a[100:103], a[0:15]
    ds_read_b64_tr_b16 a[80:81], v28 offset:20480
    ds_read_b64_tr_b16 a[82:83], v28 offset:21504
    ds_read_b128 a[108:111], v253 offset:16384
    s_add_u32 m0, s74, 57344
    s_mov_b32 s47, 320
    buffer_load_dwordx4 v32, s[32:35], s47 offen lds
    v_exp_f32 v135, v135
    v_cvt_pk_bf16_f32 v184, v128, v129
    v_cvt_pk_bf16_f32 v185, v130, v131
    v_fma_f32 v136, v136, s46, -v44
    s_waitcnt lgkmcnt(15)
    v_mfma_f32_32x32x16_bf16 a[16:31], a[84:87], a[100:103], a[16:31]
    ds_read_b64_tr_b16 a[84:85], v29 offset:20480
    ds_read_b64_tr_b16 a[86:87], v29 offset:21504
    v_fma_f32 v137, v137, s46, -v44
    v_fma_f32 v138, v138, s46, -v44
    v_fma_f32 v139, v139, s46, -v44
    v_exp_f32 v136, v136
    s_waitcnt lgkmcnt(15)
    v_mfma_f32_32x32x16_bf16 a[32:47], a[88:91], a[100:103], a[32:47]
    ds_read_b64_tr_b16 a[88:89], v30 offset:20480
    ds_read_b64_tr_b16 a[90:91], v30 offset:21504
    s_add_u32 m0, s74, 58368
    s_mov_b32 s47, 16704
    buffer_load_dwordx4 v32, s[32:35], s47 offen lds
    v_exp_f32 v137, v137
    v_exp_f32 v138, v138
    v_exp_f32 v139, v139
    v_cvt_pk_bf16_f32 v186, v132, v133
    s_waitcnt lgkmcnt(15)
    v_mfma_f32_32x32x16_bf16 a[48:63], a[92:95], a[100:103], a[48:63]
    ds_read_b64_tr_b16 a[92:93], v31 offset:20480
    ds_read_b64_tr_b16 a[94:95], v31 offset:21504
    v_cvt_pk_bf16_f32 v187, v134, v135
    v_fma_f32 v140, v140, s46, -v44
    v_fma_f32 v141, v141, s46, -v44
    v_fma_f32 v142, v142, s46, -v44
    s_waitcnt vmcnt(28)
    s_barrier
    s_waitcnt lgkmcnt(15)
    v_mfma_f32_32x32x16_bf16 a[0:15], a[64:67], a[104:107], a[0:15]
    ds_read_b64_tr_b16 a[64:65], v28 offset:32768
    ds_read_b64_tr_b16 a[66:67], v28 offset:33792
    s_add_u32 m0, s74, 65536
    s_mov_b32 s47, 1572864
    buffer_load_dwordx4 v7, s[24:27], s47 offen lds
    v_fma_f32 v143, v143, s46, -v44
    v_exp_f32 v140, v140
    v_exp_f32 v141, v141
    v_exp_f32 v142, v142
    s_waitcnt lgkmcnt(15)
    v_mfma_f32_32x32x16_bf16 a[16:31], a[68:71], a[104:107], a[16:31]
    ds_read_b64_tr_b16 a[68:69], v29 offset:32768
    ds_read_b64_tr_b16 a[70:71], v29 offset:33792
    v_exp_f32 v143, v143
    v_cvt_pk_bf16_f32 v188, v136, v137
    v_cvt_pk_bf16_f32 v189, v138, v139
    s_nop 0
    s_waitcnt lgkmcnt(15)
    v_mfma_f32_32x32x16_bf16 a[32:47], a[72:75], a[104:107], a[32:47]
    ds_read_b64_tr_b16 a[72:73], v30 offset:32768
    ds_read_b64_tr_b16 a[74:75], v30 offset:33792
    s_add_u32 m0, s74, 66560
    s_mov_b32 s47, 1605632
    buffer_load_dwordx4 v7, s[24:27], s47 offen lds
    v_cvt_pk_bf16_f32 v190, v140, v141
    v_cvt_pk_bf16_f32 v191, v142, v143
    s_waitcnt lgkmcnt(15)
    v_mfma_f32_32x32x16_bf16 a[48:63], a[76:79], a[104:107], a[48:63]
    ds_read_b64_tr_b16 a[76:77], v31 offset:32768
    ds_read_b64_tr_b16 a[78:79], v31 offset:33792
    s_waitcnt lgkmcnt(14)
    v_mfma_f32_32x32x16_bf16 a[0:15], a[80:83], a[108:111], a[0:15]
    ds_read_b64_tr_b16 a[80:81], v28 offset:36864
    ds_read_b64_tr_b16 a[82:83], v28 offset:37888
    s_add_u32 m0, s74, 73728
    s_mov_b32 s47, 384
    buffer_load_dwordx4 v32, s[32:35], s47 offen lds
    s_waitcnt lgkmcnt(14)
    v_mfma_f32_32x32x16_bf16 a[16:31], a[84:87], a[108:111], a[16:31]
    ds_read_b64_tr_b16 a[84:85], v29 offset:36864
    ds_read_b64_tr_b16 a[86:87], v29 offset:37888
    s_waitcnt lgkmcnt(14)
    v_mfma_f32_32x32x16_bf16 a[32:47], a[88:91], a[108:111], a[32:47]
    ds_read_b64_tr_b16 a[88:89], v30 offset:36864
    ds_read_b64_tr_b16 a[90:91], v30 offset:37888
    s_add_u32 m0, s74, 74752
    s_mov_b32 s47, 16768
    buffer_load_dwordx4 v32, s[32:35], s47 offen lds
    s_waitcnt lgkmcnt(14)
    v_mfma_f32_32x32x16_bf16 a[48:63], a[92:95], a[108:111], a[48:63]
    ds_read_b64_tr_b16 a[92:93], v31 offset:36864
    ds_read_b64_tr_b16 a[94:95], v31 offset:37888
    s_nop 1
    s_waitcnt vmcnt(25)
    s_barrier
    s_waitcnt lgkmcnt(14)
    v_mfma_f32_32x32x16_bf16 v[48:63], a[64:67], v[176:179], 0
    ds_read_b64_tr_b16 a[64:65], v28 offset:40960
    ds_read_b64_tr_b16 a[66:67], v28 offset:41984
    v_fma_f32 v144, v144, s46, -v44
    v_fma_f32 v145, v145, s46, -v44
    v_fma_f32 v146, v146, s46, -v44
    v_fma_f32 v147, v147, s46, -v44
    v_exp_f32 v144, v144
    v_exp_f32 v145, v145
    s_waitcnt lgkmcnt(14)
    v_mfma_f32_32x32x16_bf16 v[64:79], a[68:71], v[176:179], 0
    ds_read_b64_tr_b16 a[68:69], v29 offset:40960
    ds_read_b64_tr_b16 a[70:71], v29 offset:41984
    s_add_u32 m0, s74, 81920
    s_mov_b32 s47, 1835008
    buffer_load_dwordx4 v7, s[24:27], s47 offen lds
    v_exp_f32 v146, v146
    v_exp_f32 v147, v147
    v_fma_f32 v148, v148, s46, -v44
    v_fma_f32 v149, v149, s46, -v44
    v_fma_f32 v150, v150, s46, -v44
    v_fma_f32 v151, v151, s46, -v44
    s_waitcnt lgkmcnt(14)
    v_mfma_f32_32x32x16_bf16 v[80:95], a[72:75], v[176:179], 0
    ds_read_b64_tr_b16 a[72:73], v30 offset:40960
    ds_read_b64_tr_b16 a[74:75], v30 offset:41984
    v_exp_f32 v148, v148
    v_exp_f32 v149, v149
    v_exp_f32 v150, v150
    v_exp_f32 v151, v151
    v_cvt_pk_bf16_f32 v192, v144, v145
    v_cvt_pk_bf16_f32 v193, v146, v147
    s_waitcnt lgkmcnt(14)
    v_mfma_f32_32x32x16_bf16 v[96:111], a[76:79], v[176:179], 0
    ds_read_b64_tr_b16 a[76:77], v31 offset:40960
    ds_read_b64_tr_b16 a[78:79], v31 offset:41984
    v_fma_f32 v152, v152, s46, -v44
    v_fma_f32 v153, v153, s46, -v44
    v_fma_f32 v154, v154, s46, -v44
    v_fma_f32 v155, v155, s46, -v44
    v_exp_f32 v152, v152
    v_exp_f32 v153, v153
    s_waitcnt lgkmcnt(14)
    v_mfma_f32_32x32x16_bf16 v[48:63], a[80:83], v[180:183], v[48:63]
    ds_read_b64_tr_b16 a[80:81], v28 offset:45056
    ds_read_b64_tr_b16 a[82:83], v28 offset:46080
    v_exp_f32 v154, v154
    v_exp_f32 v155, v155
    v_cvt_pk_bf16_f32 v194, v148, v149
    v_cvt_pk_bf16_f32 v195, v150, v151
    v_fma_f32 v156, v156, s46, -v44
    v_fma_f32 v157, v157, s46, -v44
    s_waitcnt lgkmcnt(14)
    v_mfma_f32_32x32x16_bf16 v[64:79], a[84:87], v[180:183], v[64:79]
    ds_read_b64_tr_b16 a[84:85], v29 offset:45056
    ds_read_b64_tr_b16 a[86:87], v29 offset:46080
    s_add_u32 m0, s74, 82944
    s_mov_b32 s47, 1867776
    buffer_load_dwordx4 v7, s[24:27], s47 offen lds
    v_fma_f32 v158, v158, s46, -v44
    v_fma_f32 v159, v159, s46, -v44
    v_exp_f32 v156, v156
    v_exp_f32 v157, v157
    v_exp_f32 v158, v158
    v_exp_f32 v159, v159
    s_waitcnt lgkmcnt(14)
    v_mfma_f32_32x32x16_bf16 v[80:95], a[88:91], v[180:183], v[80:95]
    ds_read_b64_tr_b16 a[88:89], v30 offset:45056
    ds_read_b64_tr_b16 a[90:91], v30 offset:46080
    v_cvt_pk_bf16_f32 v196, v152, v153
    v_cvt_pk_bf16_f32 v197, v154, v155
    v_fma_f32 v160, v160, s46, -v44
    v_fma_f32 v161, v161, s46, -v44
    v_fma_f32 v162, v162, s46, -v44
    v_fma_f32 v163, v163, s46, -v44
    s_waitcnt lgkmcnt(14)
    v_mfma_f32_32x32x16_bf16 v[96:111], a[92:95], v[180:183], v[96:111]
    ds_read_b64_tr_b16 a[92:93], v31 offset:45056
    ds_read_b64_tr_b16 a[94:95], v31 offset:46080
    v_exp_f32 v160, v160
    v_exp_f32 v161, v161
    v_exp_f32 v162, v162
    v_exp_f32 v163, v163
    v_cvt_pk_bf16_f32 v198, v156, v157
    v_cvt_pk_bf16_f32 v199, v158, v159
    s_waitcnt lgkmcnt(14)
    v_mfma_f32_32x32x16_bf16 v[48:63], a[64:67], v[184:187], v[48:63]
    ds_read_b64_tr_b16 a[64:65], v28 offset:49152
    ds_read_b64_tr_b16 a[66:67], v28 offset:50176
    v_fma_f32 v164, v164, s46, -v44
    v_fma_f32 v165, v165, s46, -v44
    v_fma_f32 v166, v166, s46, -v44
    v_fma_f32 v167, v167, s46, -v44
    v_exp_f32 v164, v164
    v_exp_f32 v165, v165
    s_waitcnt lgkmcnt(14)
    v_mfma_f32_32x32x16_bf16 v[64:79], a[68:71], v[184:187], v[64:79]
    ds_read_b64_tr_b16 a[68:69], v29 offset:49152
    ds_read_b64_tr_b16 a[70:71], v29 offset:50176
    s_add_u32 m0, s74, 90112
    s_mov_b32 s47, 448
    buffer_load_dwordx4 v32, s[32:35], s47 offen lds
    v_exp_f32 v166, v166
    v_exp_f32 v167, v167
    v_cvt_pk_bf16_f32 v200, v160, v161
    v_cvt_pk_bf16_f32 v201, v162, v163
    v_fma_f32 v168, v168, s46, -v44
    v_fma_f32 v169, v169, s46, -v44
    s_waitcnt lgkmcnt(14)
    v_mfma_f32_32x32x16_bf16 v[80:95], a[72:75], v[184:187], v[80:95]
    ds_read_b64_tr_b16 a[72:73], v30 offset:49152
    ds_read_b64_tr_b16 a[74:75], v30 offset:50176
    v_fma_f32 v170, v170, s46, -v44
    v_fma_f32 v171, v171, s46, -v44
    v_exp_f32 v168, v168
    v_exp_f32 v169, v169
    v_exp_f32 v170, v170
    v_exp_f32 v171, v171
    s_waitcnt lgkmcnt(14)
    v_mfma_f32_32x32x16_bf16 v[96:111], a[76:79], v[184:187], v[96:111]
    ds_read_b64_tr_b16 a[76:77], v31 offset:49152
    ds_read_b64_tr_b16 a[78:79], v31 offset:50176
    v_cvt_pk_bf16_f32 v202, v164, v165
    v_cvt_pk_bf16_f32 v203, v166, v167
    v_fma_f32 v172, v172, s46, -v44
    v_fma_f32 v173, v173, s46, -v44
    v_fma_f32 v174, v174, s46, -v44
    v_fma_f32 v175, v175, s46, -v44
    s_waitcnt lgkmcnt(14)
    v_mfma_f32_32x32x16_bf16 v[48:63], a[80:83], v[188:191], v[48:63]
    ds_read_b64_tr_b16 a[80:81], v28 offset:53248
    ds_read_b64_tr_b16 a[82:83], v28 offset:54272
    v_exp_f32 v172, v172
    v_exp_f32 v173, v173
    v_exp_f32 v174, v174
    v_exp_f32 v175, v175
    v_cvt_pk_bf16_f32 v204, v168, v169
    v_cvt_pk_bf16_f32 v205, v170, v171
    s_waitcnt lgkmcnt(14)
    v_mfma_f32_32x32x16_bf16 v[64:79], a[84:87], v[188:191], v[64:79]
    ds_read_b64_tr_b16 a[84:85], v29 offset:53248
    ds_read_b64_tr_b16 a[86:87], v29 offset:54272
    s_add_u32 m0, s74, 91136
    s_mov_b32 s47, 16832
    buffer_load_dwordx4 v32, s[32:35], s47 offen lds
    s_nop 0
    v_cvt_pk_bf16_f32 v206, v172, v173
    v_cvt_pk_bf16_f32 v207, v174, v175
    s_waitcnt lgkmcnt(14)
    v_mfma_f32_32x32x16_bf16 v[80:95], a[88:91], v[188:191], v[80:95]
    ds_read_b64_tr_b16 a[88:89], v30 offset:53248
    ds_read_b64_tr_b16 a[90:91], v30 offset:54272
    s_waitcnt lgkmcnt(14)
    v_mfma_f32_32x32x16_bf16 v[96:111], a[92:95], v[188:191], v[96:111]
    ds_read_b64_tr_b16 a[92:93], v31 offset:53248
    ds_read_b64_tr_b16 a[94:95], v31 offset:54272
    s_nop 1
    s_waitcnt vmcnt(20)
    s_barrier
    s_waitcnt lgkmcnt(14)
    v_mfma_f32_32x32x16_bf16 v[48:63], a[64:67], v[192:195], v[48:63]
    ds_read_b64_tr_b16 a[64:65], v28 offset:57344
    ds_read_b64_tr_b16 a[66:67], v28 offset:58368
    v_add_f32 v40, v112, v113
    v_add_f32 v41, v128, v129
    v_add_f32 v42, v144, v145
    v_add_f32 v43, v160, v161
    v_add_f32 v40, v40, v114
    s_waitcnt lgkmcnt(14)
    v_mfma_f32_32x32x16_bf16 v[64:79], a[68:71], v[192:195], v[64:79]
    ds_read_b64_tr_b16 a[68:69], v29 offset:57344
    ds_read_b64_tr_b16 a[70:71], v29 offset:58368
    s_add_u32 m0, s45, 98304
    s_mov_b32 s47, 32768
    buffer_load_dwordx4 v6, s[12:15], s47 offen offset:0 nt lds
    v_add_f32 v41, v41, v130
    v_add_f32 v42, v42, v146
    v_add_f32 v43, v43, v162
    v_add_f32 v40, v40, v115
    v_add_f32 v41, v41, v131
    s_waitcnt lgkmcnt(14)
    v_mfma_f32_32x32x16_bf16 v[80:95], a[72:75], v[192:195], v[80:95]
    ds_read_b64_tr_b16 a[72:73], v30 offset:57344
    ds_read_b64_tr_b16 a[74:75], v30 offset:58368
    v_add_f32 v42, v42, v147
    v_add_f32 v43, v43, v163
    v_add_f32 v40, v40, v116
    v_add_f32 v41, v41, v132
    v_add_f32 v42, v42, v148
    s_waitcnt lgkmcnt(14)
    v_mfma_f32_32x32x16_bf16 v[96:111], a[76:79], v[192:195], v[96:111]
    ds_read_b64_tr_b16 a[76:77], v31 offset:57344
    ds_read_b64_tr_b16 a[78:79], v31 offset:58368
    v_add_f32 v43, v43, v164
    v_add_f32 v40, v40, v117
    v_add_f32 v41, v41, v133
    v_add_f32 v42, v42, v149
    v_add_f32 v43, v43, v165
    s_waitcnt lgkmcnt(14)
    v_mfma_f32_32x32x16_bf16 v[48:63], a[80:83], v[196:199], v[48:63]
    ds_read_b64_tr_b16 a[80:81], v28 offset:61440
    ds_read_b64_tr_b16 a[82:83], v28 offset:62464
    v_add_f32 v40, v40, v118
    v_add_f32 v41, v41, v134
    v_add_f32 v42, v42, v150
    v_add_f32 v43, v43, v166
    v_add_f32 v40, v40, v119
    s_waitcnt lgkmcnt(14)
    v_mfma_f32_32x32x16_bf16 v[64:79], a[84:87], v[196:199], v[64:79]
    ds_read_b64_tr_b16 a[84:85], v29 offset:61440
    ds_read_b64_tr_b16 a[86:87], v29 offset:62464
    s_add_u32 m0, s45, 98304
    s_mov_b32 s47, 32768
    buffer_load_dwordx4 v6, s[12:15], s47 offen offset:1024 nt lds
    v_add_f32 v41, v41, v135
    v_add_f32 v42, v42, v151
    v_add_f32 v43, v43, v167
    v_add_f32 v40, v40, v120
    v_add_f32 v41, v41, v136
    s_waitcnt lgkmcnt(14)
    v_mfma_f32_32x32x16_bf16 v[80:95], a[88:91], v[196:199], v[80:95]
    ds_read_b64_tr_b16 a[88:89], v30 offset:61440
    ds_read_b64_tr_b16 a[90:91], v30 offset:62464
    v_add_f32 v42, v42, v152
    v_add_f32 v43, v43, v168
    v_add_f32 v40, v40, v121
    v_add_f32 v41, v41, v137
    v_add_f32 v42, v42, v153
    s_waitcnt lgkmcnt(14)
    v_mfma_f32_32x32x16_bf16 v[96:111], a[92:95], v[196:199], v[96:111]
    ds_read_b64_tr_b16 a[92:93], v31 offset:61440
    ds_read_b64_tr_b16 a[94:95], v31 offset:62464
    v_add_f32 v43, v43, v169
    v_add_f32 v40, v40, v122
    v_add_f32 v41, v41, v138
    v_add_f32 v42, v42, v154
    v_add_f32 v43, v43, v170
    s_waitcnt lgkmcnt(14)
    v_mfma_f32_32x32x16_bf16 v[48:63], a[64:67], v[200:203], v[48:63]
    ds_read_b128 a[64:67], v8 offset:0
    v_add_f32 v40, v40, v123
    v_add_f32 v41, v41, v139
    v_add_f32 v42, v42, v155
    v_add_f32 v43, v43, v171
    v_add_f32 v40, v40, v124
    s_waitcnt lgkmcnt(13)
    v_mfma_f32_32x32x16_bf16 v[64:79], a[68:71], v[200:203], v[64:79]
    ds_read_b128 a[68:71], v9 offset:0
    s_add_u32 m0, s45, 98304
    s_mov_b32 s47, 32768
    buffer_load_dwordx4 v6, s[12:15], s47 offen offset:2048 nt lds
    v_add_f32 v41, v41, v140
    v_add_f32 v42, v42, v156
    v_add_f32 v43, v43, v172
    v_add_f32 v40, v40, v125
    v_add_f32 v41, v41, v141
    s_waitcnt lgkmcnt(12)
    v_mfma_f32_32x32x16_bf16 v[80:95], a[72:75], v[200:203], v[80:95]
    ds_read_b128 a[72:75], v10 offset:0
    v_add_f32 v42, v42, v157
    v_add_f32 v43, v43, v173
    v_add_f32 v40, v40, v126
    v_add_f32 v41, v41, v142
    v_add_f32 v42, v42, v158
    s_waitcnt lgkmcnt(11)
    v_mfma_f32_32x32x16_bf16 v[96:111], a[76:79], v[200:203], v[96:111]
    ds_read_b128 a[76:79], v11 offset:0
    v_add_f32 v43, v43, v174
    v_add_f32 v40, v40, v127
    v_add_f32 v41, v41, v143
    v_add_f32 v42, v42, v159
    v_add_f32 v43, v43, v175
    s_waitcnt lgkmcnt(10)
    v_mfma_f32_32x32x16_bf16 v[48:63], a[80:83], v[204:207], v[48:63]
    ds_read_b128 a[80:83], v12 offset:0
    v_add_f32 v40, v40, v41
    v_add_f32 v42, v42, v43
    v_add_f32 v40, v40, v42
    v_mov_b32 v35, v40
    s_waitcnt lgkmcnt(9)
    v_mfma_f32_32x32x16_bf16 v[64:79], a[84:87], v[204:207], v[64:79]
    ds_read_b128 a[84:87], v13 offset:0
    s_add_u32 m0, s45, 98304
    s_mov_b32 s47, 32768
    buffer_load_dwordx4 v6, s[12:15], s47 offen offset:3072 nt lds
    s_waitcnt lgkmcnt(8)
    v_mfma_f32_32x32x16_bf16 v[80:95], a[88:91], v[204:207], v[80:95]
    ds_read_b128 a[88:91], v14 offset:0
    s_waitcnt lgkmcnt(7)
    v_mfma_f32_32x32x16_bf16 v[96:111], a[92:95], v[204:207], v[96:111]
    ds_read_b128 a[92:95], v15 offset:0
    s_nop 1
    s_waitcnt vmcnt(20)
    s_barrier
    s_waitcnt lgkmcnt(7)
    v_mfma_f32_32x32x16_bf16 v[112:127], a[64:67], v[208:211], 0
    ds_read_b128 a[64:67], v8 offset:8192
    s_waitcnt lgkmcnt(7)
    v_mfma_f32_32x32x16_bf16 v[112:127], a[68:71], v[212:215], v[112:127]
    ds_read_b128 a[68:71], v9 offset:8192
    s_add_u32 m0, s45, 114688
    s_mov_b32 s47, 49152
    buffer_load_dwordx4 v6, s[12:15], s47 offen offset:0 nt lds
    s_waitcnt lgkmcnt(7)
    v_mfma_f32_32x32x16_bf16 v[112:127], a[72:75], v[216:219], v[112:127]
    ds_read_b128 a[72:75], v10 offset:8192
    s_waitcnt lgkmcnt(7)
    v_mfma_f32_32x32x16_bf16 v[112:127], a[76:79], v[220:223], v[112:127]
    ds_read_b128 a[76:79], v11 offset:8192
    s_waitcnt lgkmcnt(7)
    v_mfma_f32_32x32x16_bf16 v[112:127], a[80:83], v[224:227], v[112:127]
    ds_read_b128 a[80:83], v12 offset:8192
    s_waitcnt lgkmcnt(7)
    v_mfma_f32_32x32x16_bf16 v[112:127], a[84:87], v[228:231], v[112:127]
    ds_read_b128 a[84:87], v13 offset:8192
    s_add_u32 m0, s45, 114688
    s_mov_b32 s47, 49152
    buffer_load_dwordx4 v6, s[12:15], s47 offen offset:1024 nt lds
    s_waitcnt lgkmcnt(7)
    v_mfma_f32_32x32x16_bf16 v[112:127], a[88:91], v[232:235], v[112:127]
    ds_read_b128 a[88:91], v14 offset:8192
    s_waitcnt lgkmcnt(7)
    v_mfma_f32_32x32x16_bf16 v[112:127], a[92:95], v[236:239], v[112:127]
    ds_read_b128 a[92:95], v15 offset:8192
    s_waitcnt lgkmcnt(7)
    v_mfma_f32_32x32x16_bf16 v[128:143], a[64:67], v[208:211], 0
    ds_read_b128 a[64:67], v8 offset:16384
    s_waitcnt lgkmcnt(7)
    v_mfma_f32_32x32x16_bf16 v[128:143], a[68:71], v[212:215], v[128:143]
    ds_read_b128 a[68:71], v9 offset:16384
    s_add_u32 m0, s45, 114688
    s_mov_b32 s47, 49152
    buffer_load_dwordx4 v6, s[12:15], s47 offen offset:2048 nt lds
    s_waitcnt lgkmcnt(7)
    v_mfma_f32_32x32x16_bf16 v[128:143], a[72:75], v[216:219], v[128:143]
    ds_read_b128 a[72:75], v10 offset:16384
    s_waitcnt lgkmcnt(7)
    v_mfma_f32_32x32x16_bf16 v[128:143], a[76:79], v[220:223], v[128:143]
    ds_read_b128 a[76:79], v11 offset:16384
    s_waitcnt lgkmcnt(7)
    v_mfma_f32_32x32x16_bf16 v[128:143], a[80:83], v[224:227], v[128:143]
    ds_read_b128 a[80:83], v12 offset:16384
    s_waitcnt lgkmcnt(7)
    v_mfma_f32_32x32x16_bf16 v[128:143], a[84:87], v[228:231], v[128:143]
    ds_read_b128 a[84:87], v13 offset:16384
    s_add_u32 m0, s45, 114688
    s_mov_b32 s47, 49152
    buffer_load_dwordx4 v6, s[12:15], s47 offen offset:3072 nt lds
    s_waitcnt lgkmcnt(7)
    v_mfma_f32_32x32x16_bf16 v[128:143], a[88:91], v[232:235], v[128:143]
    ds_read_b128 a[88:91], v14 offset:16384
    s_waitcnt lgkmcnt(7)
    v_mfma_f32_32x32x16_bf16 v[128:143], a[92:95], v[236:239], v[128:143]
    ds_read_b128 a[92:95], v15 offset:16384
    s_nop 1
    s_waitcnt vmcnt(20)
    s_barrier
    s_waitcnt lgkmcnt(7)
    v_mfma_f32_32x32x16_bf16 v[144:159], a[64:67], v[208:211], 0
    ds_read_b128 a[64:67], v8 offset:24576
    s_nop 7
    v_max3_f32 v40, v112, v113, v114
    s_waitcnt lgkmcnt(7)
    v_mfma_f32_32x32x16_bf16 v[144:159], a[68:71], v[212:215], v[144:159]
    ds_read_b128 a[68:71], v9 offset:24576
    s_add_u32 m0, s45, 0
    s_mov_b32 s47, 65536
    buffer_load_dwordx4 v2, s[8:11], s47 offen offset:0 nt lds
    v_max3_f32 v41, v128, v129, v130
    v_max3_f32 v40, v40, v115, v116
    s_waitcnt lgkmcnt(7)
    v_mfma_f32_32x32x16_bf16 v[144:159], a[72:75], v[216:219], v[144:159]
    ds_read_b128 a[72:75], v10 offset:24576
    v_max3_f32 v41, v41, v131, v132
    v_max3_f32 v40, v40, v117, v118
    s_waitcnt lgkmcnt(7)
    v_mfma_f32_32x32x16_bf16 v[144:159], a[76:79], v[220:223], v[144:159]
    ds_read_b128 a[76:79], v11 offset:24576
    v_max3_f32 v41, v41, v133, v134
    v_max3_f32 v40, v40, v119, v120
    s_waitcnt lgkmcnt(7)
    v_mfma_f32_32x32x16_bf16 v[144:159], a[80:83], v[224:227], v[144:159]
    ds_read_b128 a[80:83], v12 offset:24576
    v_max3_f32 v41, v41, v135, v136
    v_max3_f32 v40, v40, v121, v122
    s_waitcnt lgkmcnt(7)
    v_mfma_f32_32x32x16_bf16 v[144:159], a[84:87], v[228:231], v[144:159]
    ds_read_b128 a[84:87], v13 offset:24576
    s_add_u32 m0, s45, 0
    s_mov_b32 s47, 65536
    buffer_load_dwordx4 v3, s[8:11], s47 offen offset:1024 nt lds
    v_max3_f32 v41, v41, v137, v138
    v_max3_f32 v40, v40, v123, v124
    s_waitcnt lgkmcnt(7)
    v_mfma_f32_32x32x16_bf16 v[144:159], a[88:91], v[232:235], v[144:159]
    ds_read_b128 a[88:91], v14 offset:24576
    v_max3_f32 v41, v41, v139, v140
    v_max3_f32 v40, v40, v125, v126
    s_waitcnt lgkmcnt(7)
    v_mfma_f32_32x32x16_bf16 v[144:159], a[92:95], v[236:239], v[144:159]
    ds_read_b128 a[92:95], v15 offset:24576
    v_max3_f32 v41, v41, v141, v142
    v_max_f32 v40, v40, v127
    s_waitcnt lgkmcnt(7)
    v_mfma_f32_32x32x16_bf16 v[160:175], a[64:67], v[208:211], 0
    ds_read_b64_tr_b16 a[64:65], v24 offset:32768
    ds_read_b64_tr_b16 a[66:67], v24 offset:33792
    ds_read_b128 a[96:99], v250 offset:32768
    v_max_f32 v41, v41, v143
    s_waitcnt lgkmcnt(9)
    v_mfma_f32_32x32x16_bf16 v[160:175], a[68:71], v[212:215], v[160:175]
    ds_read_b64_tr_b16 a[68:69], v25 offset:32768
    ds_read_b64_tr_b16 a[70:71], v25 offset:33792
    s_add_u32 m0, s45, 0
    s_mov_b32 s47, 65536
    buffer_load_dwordx4 v4, s[8:11], s47 offen offset:2048 nt lds
    s_waitcnt lgkmcnt(10)
    v_mfma_f32_32x32x16_bf16 v[160:175], a[72:75], v[216:219], v[160:175]
    ds_read_b64_tr_b16 a[72:73], v26 offset:32768
    ds_read_b64_tr_b16 a[74:75], v26 offset:33792
    s_waitcnt lgkmcnt(11)
    v_mfma_f32_32x32x16_bf16 v[160:175], a[76:79], v[220:223], v[160:175]
    ds_read_b64_tr_b16 a[76:77], v27 offset:32768
    ds_read_b64_tr_b16 a[78:79], v27 offset:33792
    s_waitcnt lgkmcnt(12)
    v_mfma_f32_32x32x16_bf16 v[160:175], a[80:83], v[224:227], v[160:175]
    ds_read_b64_tr_b16 a[80:81], v24 offset:36864
    ds_read_b64_tr_b16 a[82:83], v24 offset:37888
    ds_read_b128 a[100:103], v251 offset:32768
    s_waitcnt lgkmcnt(14)
    v_mfma_f32_32x32x16_bf16 v[160:175], a[84:87], v[228:231], v[160:175]
    ds_read_b64_tr_b16 a[84:85], v25 offset:36864
    ds_read_b64_tr_b16 a[86:87], v25 offset:37888
    s_add_u32 m0, s45, 0
    s_mov_b32 s47, 65536
    buffer_load_dwordx4 v5, s[8:11], s47 offen offset:3072 nt lds
    s_waitcnt lgkmcnt(15)
    v_mfma_f32_32x32x16_bf16 v[160:175], a[88:91], v[232:235], v[160:175]
    ds_read_b64_tr_b16 a[88:89], v26 offset:36864
    ds_read_b64_tr_b16 a[90:91], v26 offset:37888
    s_waitcnt lgkmcnt(15)
    v_mfma_f32_32x32x16_bf16 v[160:175], a[92:95], v[236:239], v[160:175]
    ds_read_b64_tr_b16 a[92:93], v27 offset:36864
    ds_read_b64_tr_b16 a[94:95], v27 offset:37888
    s_nop 1
    s_waitcnt vmcnt(20)
    s_barrier
    s_waitcnt lgkmcnt(15)
    v_mfma_f32_32x32x16_bf16 a[0:15], a[64:67], a[96:99], a[0:15]
    ds_read_b64_tr_b16 a[64:65], v24 offset:49152
    ds_read_b64_tr_b16 a[66:67], v24 offset:50176
    ds_read_b128 a[104:107], v250 offset:49152
    s_add_u32 m0, s45, 16384
    s_mov_b32 s47, 81920
    buffer_load_dwordx4 v2, s[8:11], s47 offen offset:0 nt lds
    s_nop 7
    v_max3_f32 v42, v144, v145, v146
    v_max3_f32 v43, v160, v161, v162
    v_max3_f32 v42, v42, v147, v148
    v_max3_f32 v43, v43, v163, v164
    v_max3_f32 v42, v42, v149, v150
    s_waitcnt lgkmcnt(15)
    v_mfma_f32_32x32x16_bf16 a[16:31], a[68:71], a[96:99], a[16:31]
    ds_read_b64_tr_b16 a[68:69], v25 offset:49152
    ds_read_b64_tr_b16 a[70:71], v25 offset:50176
    v_max3_f32 v43, v43, v165, v166
    v_max3_f32 v42, v42, v151, v152
    v_max3_f32 v43, v43, v167, v168
    v_max3_f32 v42, v42, v153, v154
    v_max3_f32 v43, v43, v169, v170
    v_max3_f32 v42, v42, v155, v156
    s_waitcnt lgkmcnt(15)
    v_mfma_f32_32x32x16_bf16 a[32:47], a[72:75], a[96:99], a[32:47]
    ds_read_b64_tr_b16 a[72:73], v26 offset:49152
    ds_read_b64_tr_b16 a[74:75], v26 offset:50176
    s_add_u32 m0, s45, 16384
    s_mov_b32 s47, 81920
    buffer_load_dwordx4 v3, s[8:11], s47 offen offset:1024 nt lds
    v_max3_f32 v43, v43, v171, v172
    v_max3_f32 v42, v42, v157, v158
    v_max3_f32 v43, v43, v173, v174
    v_max_f32 v42, v42, v159
    v_max_f32 v43, v43, v175
    v_max3_f32 v40, v40, v41, v42
    s_waitcnt lgkmcnt(15)
    v_mfma_f32_32x32x16_bf16 a[48:63], a[76:79], a[96:99], a[48:63]
    ds_read_b64_tr_b16 a[76:77], v27 offset:49152
    ds_read_b64_tr_b16 a[78:79], v27 offset:50176
    v_max_f32 v40, v40, v43
    v_mov_b32 v41, v40
    s_nop 1
    v_permlane32_swap_b32 v40, v41
    s_nop 1
    v_max3_f32 v42, v40, v41, v34
    s_waitcnt lgkmcnt(15)
    v_mfma_f32_32x32x16_bf16 a[0:15], a[80:83], a[100:103], a[0:15]
    ds_read_b64_tr_b16 a[80:81], v24 offset:53248
    ds_read_b64_tr_b16 a[82:83], v24 offset:54272
    ds_read_b128 a[108:111], v251 offset:49152
    s_add_u32 m0, s45, 16384
    s_mov_b32 s47, 81920
    buffer_load_dwordx4 v4, s[8:11], s47 offen offset:2048 nt lds
    v_sub_f32 v43, v34, v42
    v_mul_f32 v43, s46, v43
    v_exp_f32 v36, v43
    v_mov_b32 v34, v42
    v_mul_f32 v44, s46, v34
    v_fma_f32 v112, v112, s46, -v44
    s_waitcnt lgkmcnt(15)
    v_mfma_f32_32x32x16_bf16 a[16:31], a[84:87], a[100:103], a[16:31]
    ds_read_b64_tr_b16 a[84:85], v25 offset:53248
    ds_read_b64_tr_b16 a[86:87], v25 offset:54272
    v_fma_f32 v113, v113, s46, -v44
    v_fma_f32 v114, v114, s46, -v44
    v_fma_f32 v115, v115, s46, -v44
    v_exp_f32 v112, v112
    v_exp_f32 v113, v113
    v_exp_f32 v114, v114
    s_waitcnt lgkmcnt(15)
    v_mfma_f32_32x32x16_bf16 a[32:47], a[88:91], a[100:103], a[32:47]
    ds_read_b64_tr_b16 a[88:89], v26 offset:53248
    ds_read_b64_tr_b16 a[90:91], v26 offset:54272
    s_add_u32 m0, s45, 16384
    s_mov_b32 s47, 81920
    buffer_load_dwordx4 v5, s[8:11], s47 offen offset:3072 nt lds
    v_exp_f32 v115, v115
    v_mul_f32 v48, v36, v48
    v_mul_f32 v49, v36, v49
    v_mul_f32 v50, v36, v50
    v_mul_f32 v51, v36, v51
    v_mul_f32 v52, v36, v52
    s_waitcnt lgkmcnt(15)
    v_mfma_f32_32x32x16_bf16 a[48:63], a[92:95], a[100:103], a[48:63]
    ds_read_b64_tr_b16 a[92:93], v27 offset:53248
    ds_read_b64_tr_b16 a[94:95], v27 offset:54272
    v_mul_f32 v53, v36, v53
    v_mul_f32 v54, v36, v54
    v_mul_f32 v55, v36, v55
    v_fma_f32 v116, v116, s46, -v44
    v_fma_f32 v117, v117, s46, -v44
    v_fma_f32 v118, v118, s46, -v44
    s_waitcnt vmcnt(20)
    s_barrier
    s_waitcnt lgkmcnt(15)
    v_mfma_f32_32x32x16_bf16 a[0:15], a[64:67], a[104:107], a[0:15]
    ds_read_b64_tr_b16 a[64:65], v28 offset:0
    ds_read_b64_tr_b16 a[66:67], v28 offset:1024
    ds_read_b128 a[96:99], v252 offset:0
    s_add_u32 m0, s74, 32768
    s_mov_b32 s47, 2097152
    buffer_load_dwordx4 v7, s[24:27], s47 offen lds
    v_fma_f32 v119, v119, s46, -v44
    v_exp_f32 v116, v116
    v_exp_f32 v117, v117
    v_exp_f32 v118, v118
    v_exp_f32 v119, v119
    v_mul_f32 v56, v36, v56
    s_waitcnt lgkmcnt(15)
    v_mfma_f32_32x32x16_bf16 a[16:31], a[68:71], a[104:107], a[16:31]
    ds_read_b64_tr_b16 a[68:69], v29 offset:0
    ds_read_b64_tr_b16 a[70:71], v29 offset:1024
    v_mul_f32 v57, v36, v57
    v_mul_f32 v58, v36, v58
    v_mul_f32 v59, v36, v59
    v_mul_f32 v60, v36, v60
    v_mul_f32 v61, v36, v61
    v_mul_f32 v62, v36, v62
    s_waitcnt lgkmcnt(15)
    v_mfma_f32_32x32x16_bf16 a[32:47], a[72:75], a[104:107], a[32:47]
    ds_read_b64_tr_b16 a[72:73], v30 offset:0
    ds_read_b64_tr_b16 a[74:75], v30 offset:1024
    s_add_u32 m0, s74, 33792
    s_mov_b32 s47, 2129920
    buffer_load_dwordx4 v7, s[24:27], s47 offen lds
    v_mul_f32 v63, v36, v63
    v_cvt_pk_bf16_f32 v176, v112, v113
    v_cvt_pk_bf16_f32 v177, v114, v115
    v_fma_f32 v120, v120, s46, -v44
    v_fma_f32 v121, v121, s46, -v44
    v_fma_f32 v122, v122, s46, -v44
    s_waitcnt lgkmcnt(15)
    v_mfma_f32_32x32x16_bf16 a[48:63], a[76:79], a[104:107], a[48:63]
    ds_read_b64_tr_b16 a[76:77], v31 offset:0
    ds_read_b64_tr_b16 a[78:79], v31 offset:1024
    v_fma_f32 v123, v123, s46, -v44
    v_exp_f32 v120, v120
    v_exp_f32 v121, v121
    v_exp_f32 v122, v122
    v_exp_f32 v123, v123
    v_mul_f32 v64, v36, v64
    s_waitcnt lgkmcnt(15)
    v_mfma_f32_32x32x16_bf16 a[0:15], a[80:83], a[108:111], a[0:15]
    ds_read_b64_tr_b16 a[80:81], v28 offset:4096
    ds_read_b64_tr_b16 a[82:83], v28 offset:5120
    ds_read_b128 a[100:103], v253 offset:0
    s_add_u32 m0, s74, 40960
    s_mov_b32 s47, 512
    buffer_load_dwordx4 v32, s[32:35], s47 offen lds
    v_mul_f32 v65, v36, v65
    v_mul_f32 v66, v36, v66
    v_mul_f32 v67, v36, v67
    v_mul_f32 v68, v36, v68
    v_mul_f32 v69, v36, v69
    v_mul_f32 v70, v36, v70
    s_waitcnt lgkmcnt(15)
    v_mfma_f32_32x32x16_bf16 a[16:31], a[84:87], a[108:111], a[16:31]
    ds_read_b64_tr_b16 a[84:85], v29 offset:4096
    ds_read_b64_tr_b16 a[86:87], v29 offset:5120
    v_mul_f32 v71, v36, v71
    v_cvt_pk_bf16_f32 v178, v116, v117
    v_cvt_pk_bf16_f32 v179, v118, v119
    v_fma_f32 v124, v124, s46, -v44
    v_fma_f32 v125, v125, s46, -v44
    v_fma_f32 v126, v126, s46, -v44
    s_waitcnt lgkmcnt(15)
    v_mfma_f32_32x32x16_bf16 a[32:47], a[88:91], a[108:111], a[32:47]
    ds_read_b64_tr_b16 a[88:89], v30 offset:4096
    ds_read_b64_tr_b16 a[90:91], v30 offset:5120
    s_add_u32 m0, s74, 41984
    s_mov_b32 s47, 16896
    buffer_load_dwordx4 v32, s[32:35], s47 offen lds
    v_fma_f32 v127, v127, s46, -v44
    v_exp_f32 v124, v124
    v_exp_f32 v125, v125
    v_exp_f32 v126, v126
    v_exp_f32 v127, v127
    v_mul_f32 v72, v36, v72
    s_waitcnt lgkmcnt(15)
    v_mfma_f32_32x32x16_bf16 a[48:63], a[92:95], a[108:111], a[48:63]
    ds_read_b64_tr_b16 a[92:93], v31 offset:4096
    ds_read_b64_tr_b16 a[94:95], v31 offset:5120
    v_mul_f32 v73, v36, v73
    v_mul_f32 v74, v36, v74
    v_mul_f32 v75, v36, v75
    v_mul_f32 v76, v36, v76
    v_mul_f32 v77, v36, v77
    v_mul_f32 v78, v36, v78
    s_waitcnt vmcnt(20)
    s_barrier
    s_waitcnt lgkmcnt(15)
    v_mfma_f32_32x32x16_bf16 a[0:15], a[64:67], a[96:99], a[0:15]
    ds_read_b64_tr_b16 a[64:65], v28 offset:16384
    ds_read_b64_tr_b16 a[66:67], v28 offset:17408
    ds_read_b128 a[104:107], v252 offset:16384
    s_add_u32 m0, s74, 49152
    s_mov_b32 s47, 2359296
    buffer_load_dwordx4 v7, s[24:27], s47 offen lds
    v_mul_f32 v79, v36, v79
    v_cvt_pk_bf16_f32 v180, v120, v121
    v_cvt_pk_bf16_f32 v181, v122, v123
    v_fma_f32 v128, v128, s46, -v44
    v_fma_f32 v129, v129, s46, -v44
    v_fma_f32 v130, v130, s46, -v44
    s_waitcnt lgkmcnt(15)
    v_mfma_f32_32x32x16_bf16 a[16:31], a[68:71], a[96:99], a[16:31]
    ds_read_b64_tr_b16 a[68:69], v29 offset:16384
    ds_read_b64_tr_b16 a[70:71], v29 offset:17408
    v_fma_f32 v131, v131, s46, -v44
    v_exp_f32 v128, v128
    v_exp_f32 v129, v129
    v_exp_f32 v130, v130
    v_exp_f32 v131, v131
    v_mul_f32 v80, v36, v80
    s_waitcnt lgkmcnt(15)
    v_mfma_f32_32x32x16_bf16 a[32:47], a[72:75], a[96:99], a[32:47]
    ds_read_b64_tr_b16 a[72:73], v30 offset:16384
    ds_read_b64_tr_b16 a[74:75], v30 offset:17408
    s_add_u32 m0, s74, 50176
    s_mov_b32 s47, 2392064
    buffer_load_dwordx4 v7, s[24:27], s47 offen lds
    v_mul_f32 v81, v36, v81
    v_mul_f32 v82, v36, v82
    v_mul_f32 v83, v36, v83
    v_mul_f32 v84, v36, v84
    v_mul_f32 v85, v36, v85
    v_mul_f32 v86, v36, v86
    s_waitcnt lgkmcnt(15)
    v_mfma_f32_32x32x16_bf16 a[48:63], a[76:79], a[96:99], a[48:63]
    ds_read_b64_tr_b16 a[76:77], v31 offset:16384
    ds_read_b64_tr_b16 a[78:79], v31 offset:17408
    v_mul_f32 v87, v36, v87
    v_cvt_pk_bf16_f32 v182, v124, v125
    v_cvt_pk_bf16_f32 v183, v126, v127
    v_fma_f32 v132, v132, s46, -v44
    v_fma_f32 v133, v133, s46, -v44
    v_fma_f32 v134, v134, s46, -v44
    s_waitcnt lgkmcnt(15)
    v_mfma_f32_32x32x16_bf16 a[0:15], a[80:83], a[100:103], a[0:15]
    ds_read_b64_tr_b16 a[80:81], v28 offset:20480
    ds_read_b64_tr_b16 a[82:83], v28 offset:21504
    ds_read_b128 a[108:111], v253 offset:16384
    s_add_u32 m0, s74, 57344
    s_mov_b32 s47, 576
    buffer_load_dwordx4 v32, s[32:35], s47 offen lds
    v_fma_f32 v135, v135, s46, -v44
    v_exp_f32 v132, v132
    v_exp_f32 v133, v133
    v_exp_f32 v134, v134
    v_exp_f32 v135, v135
    v_mul_f32 v88, v36, v88
    s_waitcnt lgkmcnt(15)
    v_mfma_f32_32x32x16_bf16 a[16:31], a[84:87], a[100:103], a[16:31]
    ds_read_b64_tr_b16 a[84:85], v29 offset:20480
    ds_read_b64_tr_b16 a[86:87], v29 offset:21504
    v_mul_f32 v89, v36, v89
    v_mul_f32 v90, v36, v90
    v_mul_f32 v91, v36, v91
    v_mul_f32 v92, v36, v92
    v_mul_f32 v93, v36, v93
    v_mul_f32 v94, v36, v94
    s_waitcnt lgkmcnt(15)
    v_mfma_f32_32x32x16_bf16 a[32:47], a[88:91], a[100:103], a[32:47]
    ds_read_b64_tr_b16 a[88:89], v30 offset:20480
    ds_read_b64_tr_b16 a[90:91], v30 offset:21504
    s_add_u32 m0, s74, 58368
    s_mov_b32 s47, 16960
    buffer_load_dwordx4 v32, s[32:35], s47 offen lds
    v_mul_f32 v95, v36, v95
    v_cvt_pk_bf16_f32 v184, v128, v129
    v_cvt_pk_bf16_f32 v185, v130, v131
    v_fma_f32 v136, v136, s46, -v44
    v_fma_f32 v137, v137, s46, -v44
    v_fma_f32 v138, v138, s46, -v44
    s_waitcnt lgkmcnt(15)
    v_mfma_f32_32x32x16_bf16 a[48:63], a[92:95], a[100:103], a[48:63]
    ds_read_b64_tr_b16 a[92:93], v31 offset:20480
    ds_read_b64_tr_b16 a[94:95], v31 offset:21504
    v_fma_f32 v139, v139, s46, -v44
    v_exp_f32 v136, v136
    v_exp_f32 v137, v137
    v_exp_f32 v138, v138
    v_exp_f32 v139, v139
    v_mul_f32 v96, v36, v96
    s_waitcnt vmcnt(20)
    s_barrier
    s_waitcnt lgkmcnt(15)
    v_mfma_f32_32x32x16_bf16 a[0:15], a[64:67], a[104:107], a[0:15]
    ds_read_b64_tr_b16 a[64:65], v28 offset:32768
    ds_read_b64_tr_b16 a[66:67], v28 offset:33792
    s_add_u32 m0, s74, 65536
    s_mov_b32 s47, 2621440
    buffer_load_dwordx4 v7, s[24:27], s47 offen lds
    v_mul_f32 v97, v36, v97
    v_mul_f32 v98, v36, v98
    v_mul_f32 v99, v36, v99
    v_mul_f32 v100, v36, v100
    v_mul_f32 v101, v36, v101
    v_mul_f32 v102, v36, v102
    s_waitcnt lgkmcnt(15)
    v_mfma_f32_32x32x16_bf16 a[16:31], a[68:71], a[104:107], a[16:31]
    ds_read_b64_tr_b16 a[68:69], v29 offset:32768
    ds_read_b64_tr_b16 a[70:71], v29 offset:33792
    v_mul_f32 v103, v36, v103
    v_cvt_pk_bf16_f32 v186, v132, v133
    v_cvt_pk_bf16_f32 v187, v134, v135
    v_fma_f32 v140, v140, s46, -v44
    v_fma_f32 v141, v141, s46, -v44
    v_fma_f32 v142, v142, s46, -v44
    s_waitcnt lgkmcnt(15)
    v_mfma_f32_32x32x16_bf16 a[32:47], a[72:75], a[104:107], a[32:47]
    ds_read_b64_tr_b16 a[72:73], v30 offset:32768
    ds_read_b64_tr_b16 a[74:75], v30 offset:33792
    s_add_u32 m0, s74, 66560
    s_mov_b32 s47, 2654208
    buffer_load_dwordx4 v7, s[24:27], s47 offen lds
    v_fma_f32 v143, v143, s46, -v44
    v_exp_f32 v140, v140
    v_exp_f32 v141, v141
    v_exp_f32 v142, v142
    v_exp_f32 v143, v143
    v_mul_f32 v104, v36, v104
    s_waitcnt lgkmcnt(15)
    v_mfma_f32_32x32x16_bf16 a[48:63], a[76:79], a[104:107], a[48:63]
    ds_read_b64_tr_b16 a[76:77], v31 offset:32768
    ds_read_b64_tr_b16 a[78:79], v31 offset:33792
    v_mul_f32 v105, v36, v105
    v_mul_f32 v106, v36, v106
    v_mul_f32 v107, v36, v107
    v_mul_f32 v108, v36, v108
    v_mul_f32 v109, v36, v109
    v_mul_f32 v110, v36, v110
    s_waitcnt lgkmcnt(14)
    v_mfma_f32_32x32x16_bf16 a[0:15], a[80:83], a[108:111], a[0:15]
    ds_read_b64_tr_b16 a[80:81], v28 offset:36864
    ds_read_b64_tr_b16 a[82:83], v28 offset:37888
    s_add_u32 m0, s74, 73728
    s_mov_b32 s47, 640
    buffer_load_dwordx4 v32, s[32:35], s47 offen lds
    v_mul_f32 v111, v36, v111
    v_cvt_pk_bf16_f32 v188, v136, v137
    v_cvt_pk_bf16_f32 v189, v138, v139
    s_nop 0
    v_cvt_pk_bf16_f32 v190, v140, v141
    v_cvt_pk_bf16_f32 v191, v142, v143
    s_waitcnt lgkmcnt(14)
    v_mfma_f32_32x32x16_bf16 a[16:31], a[84:87], a[108:111], a[16:31]
    ds_read_b64_tr_b16 a[84:85], v29 offset:36864
    ds_read_b64_tr_b16 a[86:87], v29 offset:37888
    s_waitcnt lgkmcnt(14)
    v_mfma_f32_32x32x16_bf16 a[32:47], a[88:91], a[108:111], a[32:47]
    ds_read_b64_tr_b16 a[88:89], v30 offset:36864
    ds_read_b64_tr_b16 a[90:91], v30 offset:37888
    s_add_u32 m0, s74, 74752
    s_mov_b32 s47, 17024
    buffer_load_dwordx4 v32, s[32:35], s47 offen lds
    s_waitcnt lgkmcnt(14)
    v_mfma_f32_32x32x16_bf16 a[48:63], a[92:95], a[108:111], a[48:63]
    ds_read_b64_tr_b16 a[92:93], v31 offset:36864
    ds_read_b64_tr_b16 a[94:95], v31 offset:37888
    s_nop 1
    s_waitcnt vmcnt(20)
    s_barrier
    s_waitcnt lgkmcnt(14)
    v_mfma_f32_32x32x16_bf16 v[48:63], a[64:67], v[176:179], v[48:63]
    ds_read_b64_tr_b16 a[64:65], v28 offset:40960
    ds_read_b64_tr_b16 a[66:67], v28 offset:41984
    v_fma_f32 v144, v144, s46, -v44
    v_fma_f32 v145, v145, s46, -v44
    v_fma_f32 v146, v146, s46, -v44
    v_fma_f32 v147, v147, s46, -v44
    v_exp_f32 v144, v144
    v_exp_f32 v145, v145
    s_waitcnt lgkmcnt(14)
    v_mfma_f32_32x32x16_bf16 v[64:79], a[68:71], v[176:179], v[64:79]
    ds_read_b64_tr_b16 a[68:69], v29 offset:40960
    ds_read_b64_tr_b16 a[70:71], v29 offset:41984
    s_add_u32 m0, s74, 81920
    s_mov_b32 s47, 2883584
    buffer_load_dwordx4 v7, s[24:27], s47 offen lds
    v_exp_f32 v146, v146
    v_exp_f32 v147, v147
    v_fma_f32 v148, v148, s46, -v44
    v_fma_f32 v149, v149, s46, -v44
    v_fma_f32 v150, v150, s46, -v44
    v_fma_f32 v151, v151, s46, -v44
    s_waitcnt lgkmcnt(14)
    v_mfma_f32_32x32x16_bf16 v[80:95], a[72:75], v[176:179], v[80:95]
    ds_read_b64_tr_b16 a[72:73], v30 offset:40960
    ds_read_b64_tr_b16 a[74:75], v30 offset:41984
    v_exp_f32 v148, v148
    v_exp_f32 v149, v149
    v_exp_f32 v150, v150
    v_exp_f32 v151, v151
    v_cvt_pk_bf16_f32 v192, v144, v145
    v_cvt_pk_bf16_f32 v193, v146, v147
    s_waitcnt lgkmcnt(14)
    v_mfma_f32_32x32x16_bf16 v[96:111], a[76:79], v[176:179], v[96:111]
    ds_read_b64_tr_b16 a[76:77], v31 offset:40960
    ds_read_b64_tr_b16 a[78:79], v31 offset:41984
    v_fma_f32 v152, v152, s46, -v44
    v_fma_f32 v153, v153, s46, -v44
    v_fma_f32 v154, v154, s46, -v44
    v_fma_f32 v155, v155, s46, -v44
    v_exp_f32 v152, v152
    v_exp_f32 v153, v153
    s_waitcnt lgkmcnt(14)
    v_mfma_f32_32x32x16_bf16 v[48:63], a[80:83], v[180:183], v[48:63]
    ds_read_b64_tr_b16 a[80:81], v28 offset:45056
    ds_read_b64_tr_b16 a[82:83], v28 offset:46080
    v_exp_f32 v154, v154
    v_exp_f32 v155, v155
    v_cvt_pk_bf16_f32 v194, v148, v149
    v_cvt_pk_bf16_f32 v195, v150, v151
    v_fma_f32 v156, v156, s46, -v44
    v_fma_f32 v157, v157, s46, -v44
    s_waitcnt lgkmcnt(14)
    v_mfma_f32_32x32x16_bf16 v[64:79], a[84:87], v[180:183], v[64:79]
    ds_read_b64_tr_b16 a[84:85], v29 offset:45056
    ds_read_b64_tr_b16 a[86:87], v29 offset:46080
    s_add_u32 m0, s74, 82944
    s_mov_b32 s47, 2916352
    buffer_load_dwordx4 v7, s[24:27], s47 offen lds
    v_fma_f32 v158, v158, s46, -v44
    v_fma_f32 v159, v159, s46, -v44
    v_exp_f32 v156, v156
    v_exp_f32 v157, v157
    v_exp_f32 v158, v158
    v_exp_f32 v159, v159
    s_waitcnt lgkmcnt(14)
    v_mfma_f32_32x32x16_bf16 v[80:95], a[88:91], v[180:183], v[80:95]
    ds_read_b64_tr_b16 a[88:89], v30 offset:45056
    ds_read_b64_tr_b16 a[90:91], v30 offset:46080
    v_cvt_pk_bf16_f32 v196, v152, v153
    v_cvt_pk_bf16_f32 v197, v154, v155
    v_fma_f32 v160, v160, s46, -v44
    v_fma_f32 v161, v161, s46, -v44
    v_fma_f32 v162, v162, s46, -v44
    v_fma_f32 v163, v163, s46, -v44
    s_waitcnt lgkmcnt(14)
    v_mfma_f32_32x32x16_bf16 v[96:111], a[92:95], v[180:183], v[96:111]
    ds_read_b64_tr_b16 a[92:93], v31 offset:45056
    ds_read_b64_tr_b16 a[94:95], v31 offset:46080
    v_exp_f32 v160, v160
    v_exp_f32 v161, v161
    v_exp_f32 v162, v162
    v_exp_f32 v163, v163
    v_cvt_pk_bf16_f32 v198, v156, v157
    v_cvt_pk_bf16_f32 v199, v158, v159
    s_waitcnt lgkmcnt(14)
    v_mfma_f32_32x32x16_bf16 v[48:63], a[64:67], v[184:187], v[48:63]
    ds_read_b64_tr_b16 a[64:65], v28 offset:49152
    ds_read_b64_tr_b16 a[66:67], v28 offset:50176
    v_fma_f32 v164, v164, s46, -v44
    v_fma_f32 v165, v165, s46, -v44
    v_fma_f32 v166, v166, s46, -v44
    v_fma_f32 v167, v167, s46, -v44
    v_exp_f32 v164, v164
    v_exp_f32 v165, v165
    s_waitcnt lgkmcnt(14)
    v_mfma_f32_32x32x16_bf16 v[64:79], a[68:71], v[184:187], v[64:79]
    ds_read_b64_tr_b16 a[68:69], v29 offset:49152
    ds_read_b64_tr_b16 a[70:71], v29 offset:50176
    s_add_u32 m0, s74, 90112
    s_mov_b32 s47, 704
    buffer_load_dwordx4 v32, s[32:35], s47 offen lds
    v_exp_f32 v166, v166
    v_exp_f32 v167, v167
    v_cvt_pk_bf16_f32 v200, v160, v161
    v_cvt_pk_bf16_f32 v201, v162, v163
    v_fma_f32 v168, v168, s46, -v44
    v_fma_f32 v169, v169, s46, -v44
    s_waitcnt lgkmcnt(14)
    v_mfma_f32_32x32x16_bf16 v[80:95], a[72:75], v[184:187], v[80:95]
    ds_read_b64_tr_b16 a[72:73], v30 offset:49152
    ds_read_b64_tr_b16 a[74:75], v30 offset:50176
    v_fma_f32 v170, v170, s46, -v44
    v_fma_f32 v171, v171, s46, -v44
    v_exp_f32 v168, v168
    v_exp_f32 v169, v169
    v_exp_f32 v170, v170
    v_exp_f32 v171, v171
    s_waitcnt lgkmcnt(14)
    v_mfma_f32_32x32x16_bf16 v[96:111], a[76:79], v[184:187], v[96:111]
    ds_read_b64_tr_b16 a[76:77], v31 offset:49152
    ds_read_b64_tr_b16 a[78:79], v31 offset:50176
    v_cvt_pk_bf16_f32 v202, v164, v165
    v_cvt_pk_bf16_f32 v203, v166, v167
    v_fma_f32 v172, v172, s46, -v44
    v_fma_f32 v173, v173, s46, -v44
    v_fma_f32 v174, v174, s46, -v44
    v_fma_f32 v175, v175, s46, -v44
    s_waitcnt lgkmcnt(14)
    v_mfma_f32_32x32x16_bf16 v[48:63], a[80:83], v[188:191], v[48:63]
    ds_read_b64_tr_b16 a[80:81], v28 offset:53248
    ds_read_b64_tr_b16 a[82:83], v28 offset:54272
    v_exp_f32 v172, v172
    v_exp_f32 v173, v173
    v_exp_f32 v174, v174
    v_exp_f32 v175, v175
    v_cvt_pk_bf16_f32 v204, v168, v169
    v_cvt_pk_bf16_f32 v205, v170, v171
    s_waitcnt lgkmcnt(14)
    v_mfma_f32_32x32x16_bf16 v[64:79], a[84:87], v[188:191], v[64:79]
    ds_read_b64_tr_b16 a[84:85], v29 offset:53248
    ds_read_b64_tr_b16 a[86:87], v29 offset:54272
    s_add_u32 m0, s74, 91136
    s_mov_b32 s47, 17088
    buffer_load_dwordx4 v32, s[32:35], s47 offen lds
    s_nop 0
    v_cvt_pk_bf16_f32 v206, v172, v173
    v_cvt_pk_bf16_f32 v207, v174, v175
    s_waitcnt lgkmcnt(14)
    v_mfma_f32_32x32x16_bf16 v[80:95], a[88:91], v[188:191], v[80:95]
    ds_read_b64_tr_b16 a[88:89], v30 offset:53248
    ds_read_b64_tr_b16 a[90:91], v30 offset:54272
    s_waitcnt lgkmcnt(14)
    v_mfma_f32_32x32x16_bf16 v[96:111], a[92:95], v[188:191], v[96:111]
    ds_read_b64_tr_b16 a[92:93], v31 offset:53248
    ds_read_b64_tr_b16 a[94:95], v31 offset:54272
    s_nop 1
    s_waitcnt vmcnt(20)
    s_barrier
    s_waitcnt lgkmcnt(14)
    v_mfma_f32_32x32x16_bf16 v[48:63], a[64:67], v[192:195], v[48:63]
    ds_read_b64_tr_b16 a[64:65], v28 offset:57344
    ds_read_b64_tr_b16 a[66:67], v28 offset:58368
    v_add_f32 v40, v112, v113
    v_add_f32 v41, v128, v129
    v_add_f32 v42, v144, v145
    v_add_f32 v43, v160, v161
    v_add_f32 v40, v40, v114
    s_waitcnt lgkmcnt(14)
    v_mfma_f32_32x32x16_bf16 v[64:79], a[68:71], v[192:195], v[64:79]
    ds_read_b64_tr_b16 a[68:69], v29 offset:57344
    ds_read_b64_tr_b16 a[70:71], v29 offset:58368
    s_add_u32 m0, s45, 98304
    s_mov_b32 s47, 65536
    buffer_load_dwordx4 v6, s[12:15], s47 offen offset:0 nt lds
    v_add_f32 v41, v41, v130
    v_add_f32 v42, v42, v146
    v_add_f32 v43, v43, v162
    v_add_f32 v40, v40, v115
    v_add_f32 v41, v41, v131
    s_waitcnt lgkmcnt(14)
    v_mfma_f32_32x32x16_bf16 v[80:95], a[72:75], v[192:195], v[80:95]
    ds_read_b64_tr_b16 a[72:73], v30 offset:57344
    ds_read_b64_tr_b16 a[74:75], v30 offset:58368
    v_add_f32 v42, v42, v147
    v_add_f32 v43, v43, v163
    v_add_f32 v40, v40, v116
    v_add_f32 v41, v41, v132
    v_add_f32 v42, v42, v148
    s_waitcnt lgkmcnt(14)
    v_mfma_f32_32x32x16_bf16 v[96:111], a[76:79], v[192:195], v[96:111]
    ds_read_b64_tr_b16 a[76:77], v31 offset:57344
    ds_read_b64_tr_b16 a[78:79], v31 offset:58368
    v_add_f32 v43, v43, v164
    v_add_f32 v40, v40, v117
    v_add_f32 v41, v41, v133
    v_add_f32 v42, v42, v149
    v_add_f32 v43, v43, v165
    s_waitcnt lgkmcnt(14)
    v_mfma_f32_32x32x16_bf16 v[48:63], a[80:83], v[196:199], v[48:63]
    ds_read_b64_tr_b16 a[80:81], v28 offset:61440
    ds_read_b64_tr_b16 a[82:83], v28 offset:62464
    v_add_f32 v40, v40, v118
    v_add_f32 v41, v41, v134
    v_add_f32 v42, v42, v150
    v_add_f32 v43, v43, v166
    v_add_f32 v40, v40, v119
    s_waitcnt lgkmcnt(14)
    v_mfma_f32_32x32x16_bf16 v[64:79], a[84:87], v[196:199], v[64:79]
    ds_read_b64_tr_b16 a[84:85], v29 offset:61440
    ds_read_b64_tr_b16 a[86:87], v29 offset:62464
    s_add_u32 m0, s45, 98304
    s_mov_b32 s47, 65536
    buffer_load_dwordx4 v6, s[12:15], s47 offen offset:1024 nt lds
    v_add_f32 v41, v41, v135
    v_add_f32 v42, v42, v151
    v_add_f32 v43, v43, v167
    v_add_f32 v40, v40, v120
    v_add_f32 v41, v41, v136
    s_waitcnt lgkmcnt(14)
    v_mfma_f32_32x32x16_bf16 v[80:95], a[88:91], v[196:199], v[80:95]
    ds_read_b64_tr_b16 a[88:89], v30 offset:61440
    ds_read_b64_tr_b16 a[90:91], v30 offset:62464
    v_add_f32 v42, v42, v152
    v_add_f32 v43, v43, v168
    v_add_f32 v40, v40, v121
    v_add_f32 v41, v41, v137
    v_add_f32 v42, v42, v153
    s_waitcnt lgkmcnt(14)
    v_mfma_f32_32x32x16_bf16 v[96:111], a[92:95], v[196:199], v[96:111]
    ds_read_b64_tr_b16 a[92:93], v31 offset:61440
    ds_read_b64_tr_b16 a[94:95], v31 offset:62464
    v_add_f32 v43, v43, v169
    v_add_f32 v40, v40, v122
    v_add_f32 v41, v41, v138
    v_add_f32 v42, v42, v154
    v_add_f32 v43, v43, v170
    s_waitcnt lgkmcnt(14)
    v_mfma_f32_32x32x16_bf16 v[48:63], a[64:67], v[200:203], v[48:63]
    ds_read_b128 a[64:67], v8 offset:0
    v_add_f32 v40, v40, v123
    v_add_f32 v41, v41, v139
    v_add_f32 v42, v42, v155
    v_add_f32 v43, v43, v171
    v_add_f32 v40, v40, v124
    s_waitcnt lgkmcnt(13)
    v_mfma_f32_32x32x16_bf16 v[64:79], a[68:71], v[200:203], v[64:79]
    ds_read_b128 a[68:71], v9 offset:0
    s_add_u32 m0, s45, 98304
    s_mov_b32 s47, 65536
    buffer_load_dwordx4 v6, s[12:15], s47 offen offset:2048 nt lds
    v_add_f32 v41, v41, v140
    v_add_f32 v42, v42, v156
    v_add_f32 v43, v43, v172
    v_add_f32 v40, v40, v125
    v_add_f32 v41, v41, v141
    s_waitcnt lgkmcnt(12)
    v_mfma_f32_32x32x16_bf16 v[80:95], a[72:75], v[200:203], v[80:95]
    ds_read_b128 a[72:75], v10 offset:0
    v_add_f32 v42, v42, v157
    v_add_f32 v43, v43, v173
    v_add_f32 v40, v40, v126
    v_add_f32 v41, v41, v142
    v_add_f32 v42, v42, v158
    s_waitcnt lgkmcnt(11)
    v_mfma_f32_32x32x16_bf16 v[96:111], a[76:79], v[200:203], v[96:111]
    ds_read_b128 a[76:79], v11 offset:0
    v_add_f32 v43, v43, v174
    v_add_f32 v40, v40, v127
    v_add_f32 v41, v41, v143
    v_add_f32 v42, v42, v159
    v_add_f32 v43, v43, v175
    s_waitcnt lgkmcnt(10)
    v_mfma_f32_32x32x16_bf16 v[48:63], a[80:83], v[204:207], v[48:63]
    ds_read_b128 a[80:83], v12 offset:0
    v_add_f32 v40, v40, v41
    v_add_f32 v42, v42, v43
    v_add_f32 v40, v40, v42
    v_fma_f32 v35, v35, v36, v40
    s_waitcnt lgkmcnt(9)
    v_mfma_f32_32x32x16_bf16 v[64:79], a[84:87], v[204:207], v[64:79]
    ds_read_b128 a[84:87], v13 offset:0
    s_add_u32 m0, s45, 98304
    s_mov_b32 s47, 65536
    buffer_load_dwordx4 v6, s[12:15], s47 offen offset:3072 nt lds
    s_waitcnt lgkmcnt(8)
    v_mfma_f32_32x32x16_bf16 v[80:95], a[88:91], v[204:207], v[80:95]
    ds_read_b128 a[88:91], v14 offset:0
    s_waitcnt lgkmcnt(7)
    v_mfma_f32_32x32x16_bf16 v[96:111], a[92:95], v[204:207], v[96:111]
    ds_read_b128 a[92:95], v15 offset:0
    s_nop 1
    s_waitcnt vmcnt(20)
    s_barrier
    s_waitcnt lgkmcnt(7)
    v_mfma_f32_32x32x16_bf16 v[112:127], a[64:67], v[208:211], 0
    ds_read_b128 a[64:67], v8 offset:8192
    s_waitcnt lgkmcnt(7)
    v_mfma_f32_32x32x16_bf16 v[112:127], a[68:71], v[212:215], v[112:127]
    ds_read_b128 a[68:71], v9 offset:8192
    s_add_u32 m0, s45, 114688
    s_mov_b32 s47, 81920
    buffer_load_dwordx4 v6, s[12:15], s47 offen offset:0 nt lds
    s_waitcnt lgkmcnt(7)
    v_mfma_f32_32x32x16_bf16 v[112:127], a[72:75], v[216:219], v[112:127]
    ds_read_b128 a[72:75], v10 offset:8192
    s_waitcnt lgkmcnt(7)
    v_mfma_f32_32x32x16_bf16 v[112:127], a[76:79], v[220:223], v[112:127]
    ds_read_b128 a[76:79], v11 offset:8192
    s_waitcnt lgkmcnt(7)
    v_mfma_f32_32x32x16_bf16 v[112:127], a[80:83], v[224:227], v[112:127]
    ds_read_b128 a[80:83], v12 offset:8192
    s_waitcnt lgkmcnt(7)
    v_mfma_f32_32x32x16_bf16 v[112:127], a[84:87], v[228:231], v[112:127]
    ds_read_b128 a[84:87], v13 offset:8192
    s_add_u32 m0, s45, 114688
    s_mov_b32 s47, 81920
    buffer_load_dwordx4 v6, s[12:15], s47 offen offset:1024 nt lds
    s_waitcnt lgkmcnt(7)
    v_mfma_f32_32x32x16_bf16 v[112:127], a[88:91], v[232:235], v[112:127]
    ds_read_b128 a[88:91], v14 offset:8192
    s_waitcnt lgkmcnt(7)
    v_mfma_f32_32x32x16_bf16 v[112:127], a[92:95], v[236:239], v[112:127]
    ds_read_b128 a[92:95], v15 offset:8192
    s_waitcnt lgkmcnt(7)
    v_mfma_f32_32x32x16_bf16 v[128:143], a[64:67], v[208:211], 0
    ds_read_b128 a[64:67], v8 offset:16384
    s_waitcnt lgkmcnt(7)
    v_mfma_f32_32x32x16_bf16 v[128:143], a[68:71], v[212:215], v[128:143]
    ds_read_b128 a[68:71], v9 offset:16384
    s_add_u32 m0, s45, 114688
    s_mov_b32 s47, 81920
    buffer_load_dwordx4 v6, s[12:15], s47 offen offset:2048 nt lds
    s_waitcnt lgkmcnt(7)
    v_mfma_f32_32x32x16_bf16 v[128:143], a[72:75], v[216:219], v[128:143]
    ds_read_b128 a[72:75], v10 offset:16384
    s_waitcnt lgkmcnt(7)
    v_mfma_f32_32x32x16_bf16 v[128:143], a[76:79], v[220:223], v[128:143]
    ds_read_b128 a[76:79], v11 offset:16384
    s_waitcnt lgkmcnt(7)
    v_mfma_f32_32x32x16_bf16 v[128:143], a[80:83], v[224:227], v[128:143]
    ds_read_b128 a[80:83], v12 offset:16384
    s_waitcnt lgkmcnt(7)
    v_mfma_f32_32x32x16_bf16 v[128:143], a[84:87], v[228:231], v[128:143]
    ds_read_b128 a[84:87], v13 offset:16384
    s_add_u32 m0, s45, 114688
    s_mov_b32 s47, 81920
    buffer_load_dwordx4 v6, s[12:15], s47 offen offset:3072 nt lds
    s_waitcnt lgkmcnt(7)
    v_mfma_f32_32x32x16_bf16 v[128:143], a[88:91], v[232:235], v[128:143]
    ds_read_b128 a[88:91], v14 offset:16384
    s_waitcnt lgkmcnt(7)
    v_mfma_f32_32x32x16_bf16 v[128:143], a[92:95], v[236:239], v[128:143]
    ds_read_b128 a[92:95], v15 offset:16384
    s_nop 1
    s_waitcnt vmcnt(20)
    s_barrier
    s_waitcnt lgkmcnt(7)
    v_mfma_f32_32x32x16_bf16 v[144:159], a[64:67], v[208:211], 0
    ds_read_b128 a[64:67], v8 offset:24576
    s_nop 7
    v_max3_f32 v40, v112, v113, v114
    s_waitcnt lgkmcnt(7)
    v_mfma_f32_32x32x16_bf16 v[144:159], a[68:71], v[212:215], v[144:159]
    ds_read_b128 a[68:71], v9 offset:24576
    s_add_u32 m0, s45, 0
    s_mov_b32 s47, 98304
    buffer_load_dwordx4 v2, s[8:11], s47 offen offset:0 nt lds
    v_max3_f32 v41, v128, v129, v130
    v_max3_f32 v40, v40, v115, v116
    s_waitcnt lgkmcnt(7)
    v_mfma_f32_32x32x16_bf16 v[144:159], a[72:75], v[216:219], v[144:159]
    ds_read_b128 a[72:75], v10 offset:24576
    v_max3_f32 v41, v41, v131, v132
    v_max3_f32 v40, v40, v117, v118
    s_waitcnt lgkmcnt(7)
    v_mfma_f32_32x32x16_bf16 v[144:159], a[76:79], v[220:223], v[144:159]
    ds_read_b128 a[76:79], v11 offset:24576
    v_max3_f32 v41, v41, v133, v134
    v_max3_f32 v40, v40, v119, v120
    s_waitcnt lgkmcnt(7)
    v_mfma_f32_32x32x16_bf16 v[144:159], a[80:83], v[224:227], v[144:159]
    ds_read_b128 a[80:83], v12 offset:24576
    v_max3_f32 v41, v41, v135, v136
    v_max3_f32 v40, v40, v121, v122
    s_waitcnt lgkmcnt(7)
    v_mfma_f32_32x32x16_bf16 v[144:159], a[84:87], v[228:231], v[144:159]
    ds_read_b128 a[84:87], v13 offset:24576
    s_add_u32 m0, s45, 0
    s_mov_b32 s47, 98304
    buffer_load_dwordx4 v3, s[8:11], s47 offen offset:1024 nt lds
    v_max3_f32 v41, v41, v137, v138
    v_max3_f32 v40, v40, v123, v124
    s_waitcnt lgkmcnt(7)
    v_mfma_f32_32x32x16_bf16 v[144:159], a[88:91], v[232:235], v[144:159]
    ds_read_b128 a[88:91], v14 offset:24576
    v_max3_f32 v41, v41, v139, v140
    v_max3_f32 v40, v40, v125, v126
    s_waitcnt lgkmcnt(7)
    v_mfma_f32_32x32x16_bf16 v[144:159], a[92:95], v[236:239], v[144:159]
    ds_read_b128 a[92:95], v15 offset:24576
    v_max3_f32 v41, v41, v141, v142
    v_max_f32 v40, v40, v127
    s_waitcnt lgkmcnt(7)
    v_mfma_f32_32x32x16_bf16 v[160:175], a[64:67], v[208:211], 0
    ds_read_b64_tr_b16 a[64:65], v24 offset:32768
    ds_read_b64_tr_b16 a[66:67], v24 offset:33792
    ds_read_b128 a[96:99], v250 offset:32768
    v_max_f32 v41, v41, v143
    s_waitcnt lgkmcnt(9)
    v_mfma_f32_32x32x16_bf16 v[160:175], a[68:71], v[212:215], v[160:175]
    ds_read_b64_tr_b16 a[68:69], v25 offset:32768
    ds_read_b64_tr_b16 a[70:71], v25 offset:33792
    s_add_u32 m0, s45, 0
    s_mov_b32 s47, 98304
    buffer_load_dwordx4 v4, s[8:11], s47 offen offset:2048 nt lds
    s_waitcnt lgkmcnt(10)
    v_mfma_f32_32x32x16_bf16 v[160:175], a[72:75], v[216:219], v[160:175]
    ds_read_b64_tr_b16 a[72:73], v26 offset:32768
    ds_read_b64_tr_b16 a[74:75], v26 offset:33792
    s_waitcnt lgkmcnt(11)
    v_mfma_f32_32x32x16_bf16 v[160:175], a[76:79], v[220:223], v[160:175]
    ds_read_b64_tr_b16 a[76:77], v27 offset:32768
    ds_read_b64_tr_b16 a[78:79], v27 offset:33792
    s_waitcnt lgkmcnt(12)
    v_mfma_f32_32x32x16_bf16 v[160:175], a[80:83], v[224:227], v[160:175]
    ds_read_b64_tr_b16 a[80:81], v24 offset:36864
    ds_read_b64_tr_b16 a[82:83], v24 offset:37888
    ds_read_b128 a[100:103], v251 offset:32768
    s_waitcnt lgkmcnt(14)
    v_mfma_f32_32x32x16_bf16 v[160:175], a[84:87], v[228:231], v[160:175]
    ds_read_b64_tr_b16 a[84:85], v25 offset:36864
    ds_read_b64_tr_b16 a[86:87], v25 offset:37888
    s_add_u32 m0, s45, 0
    s_mov_b32 s47, 98304
    buffer_load_dwordx4 v5, s[8:11], s47 offen offset:3072 nt lds
    s_waitcnt lgkmcnt(15)
    v_mfma_f32_32x32x16_bf16 v[160:175], a[88:91], v[232:235], v[160:175]
    ds_read_b64_tr_b16 a[88:89], v26 offset:36864
    ds_read_b64_tr_b16 a[90:91], v26 offset:37888
    s_waitcnt lgkmcnt(15)
    v_mfma_f32_32x32x16_bf16 v[160:175], a[92:95], v[236:239], v[160:175]
    ds_read_b64_tr_b16 a[92:93], v27 offset:36864
    ds_read_b64_tr_b16 a[94:95], v27 offset:37888
    s_nop 1
    s_waitcnt vmcnt(20)
    s_barrier
    s_waitcnt lgkmcnt(15)
    v_mfma_f32_32x32x16_bf16 a[0:15], a[64:67], a[96:99], a[0:15]
    ds_read_b64_tr_b16 a[64:65], v24 offset:49152
    ds_read_b64_tr_b16 a[66:67], v24 offset:50176
    ds_read_b128 a[104:107], v250 offset:49152
    s_add_u32 m0, s45, 16384
    s_mov_b32 s47, 114688
    buffer_load_dwordx4 v2, s[8:11], s47 offen offset:0 nt lds
    s_nop 7
    v_max3_f32 v42, v144, v145, v146
    v_max3_f32 v43, v160, v161, v162
    v_max3_f32 v42, v42, v147, v148
    v_max3_f32 v43, v43, v163, v164
    v_max3_f32 v42, v42, v149, v150
    s_waitcnt lgkmcnt(15)
    v_mfma_f32_32x32x16_bf16 a[16:31], a[68:71], a[96:99], a[16:31]
    ds_read_b64_tr_b16 a[68:69], v25 offset:49152
    ds_read_b64_tr_b16 a[70:71], v25 offset:50176
    v_max3_f32 v43, v43, v165, v166
    v_max3_f32 v42, v42, v151, v152
    v_max3_f32 v43, v43, v167, v168
    v_max3_f32 v42, v42, v153, v154
    v_max3_f32 v43, v43, v169, v170
    v_max3_f32 v42, v42, v155, v156
    s_waitcnt lgkmcnt(15)
    v_mfma_f32_32x32x16_bf16 a[32:47], a[72:75], a[96:99], a[32:47]
    ds_read_b64_tr_b16 a[72:73], v26 offset:49152
    ds_read_b64_tr_b16 a[74:75], v26 offset:50176
    s_add_u32 m0, s45, 16384
    s_mov_b32 s47, 114688
    buffer_load_dwordx4 v3, s[8:11], s47 offen offset:1024 nt lds
    v_max3_f32 v43, v43, v171, v172
    v_max3_f32 v42, v42, v157, v158
    v_max3_f32 v43, v43, v173, v174
    v_max_f32 v42, v42, v159
    v_max_f32 v43, v43, v175
    v_max3_f32 v40, v40, v41, v42
    s_waitcnt lgkmcnt(15)
    v_mfma_f32_32x32x16_bf16 a[48:63], a[76:79], a[96:99], a[48:63]
    ds_read_b64_tr_b16 a[76:77], v27 offset:49152
    ds_read_b64_tr_b16 a[78:79], v27 offset:50176
    v_max_f32 v40, v40, v43
    v_mov_b32 v41, v40
    s_nop 1
    v_permlane32_swap_b32 v40, v41
    s_nop 1
    v_max3_f32 v42, v40, v41, v34
    s_waitcnt lgkmcnt(15)
    v_mfma_f32_32x32x16_bf16 a[0:15], a[80:83], a[100:103], a[0:15]
    ds_read_b64_tr_b16 a[80:81], v24 offset:53248
    ds_read_b64_tr_b16 a[82:83], v24 offset:54272
    ds_read_b128 a[108:111], v251 offset:49152
    s_add_u32 m0, s45, 16384
    s_mov_b32 s47, 114688
    buffer_load_dwordx4 v4, s[8:11], s47 offen offset:2048 nt lds
    v_sub_f32 v43, v34, v42
    v_mul_f32 v43, s46, v43
    v_exp_f32 v36, v43
    v_mov_b32 v34, v42
    v_mul_f32 v44, s46, v34
    v_fma_f32 v112, v112, s46, -v44
    s_waitcnt lgkmcnt(15)
    v_mfma_f32_32x32x16_bf16 a[16:31], a[84:87], a[100:103], a[16:31]
    ds_read_b64_tr_b16 a[84:85], v25 offset:53248
    ds_read_b64_tr_b16 a[86:87], v25 offset:54272
    v_fma_f32 v113, v113, s46, -v44
    v_fma_f32 v114, v114, s46, -v44
    v_fma_f32 v115, v115, s46, -v44
    v_exp_f32 v112, v112
    v_exp_f32 v113, v113
    v_exp_f32 v114, v114
    s_waitcnt lgkmcnt(15)
    v_mfma_f32_32x32x16_bf16 a[32:47], a[88:91], a[100:103], a[32:47]
    ds_read_b64_tr_b16 a[88:89], v26 offset:53248
    ds_read_b64_tr_b16 a[90:91], v26 offset:54272
    s_add_u32 m0, s45, 16384
    s_mov_b32 s47, 114688
    buffer_load_dwordx4 v5, s[8:11], s47 offen offset:3072 nt lds
    v_exp_f32 v115, v115
    v_mul_f32 v48, v36, v48
    v_mul_f32 v49, v36, v49
    v_mul_f32 v50, v36, v50
    v_mul_f32 v51, v36, v51
    v_mul_f32 v52, v36, v52
    s_waitcnt lgkmcnt(15)
    v_mfma_f32_32x32x16_bf16 a[48:63], a[92:95], a[100:103], a[48:63]
    ds_read_b64_tr_b16 a[92:93], v27 offset:53248
    ds_read_b64_tr_b16 a[94:95], v27 offset:54272
    v_mul_f32 v53, v36, v53
    v_mul_f32 v54, v36, v54
    v_mul_f32 v55, v36, v55
    v_fma_f32 v116, v116, s46, -v44
    v_fma_f32 v117, v117, s46, -v44
    v_fma_f32 v118, v118, s46, -v44
    s_waitcnt vmcnt(20)
    s_barrier
    s_waitcnt lgkmcnt(15)
    v_mfma_f32_32x32x16_bf16 a[0:15], a[64:67], a[104:107], a[0:15]
    ds_read_b64_tr_b16 a[64:65], v28 offset:0
    ds_read_b64_tr_b16 a[66:67], v28 offset:1024
    ds_read_b128 a[96:99], v252 offset:0
    s_add_u32 m0, s74, 32768
    s_mov_b32 s47, 3145728
    buffer_load_dwordx4 v7, s[24:27], s47 offen lds
    v_fma_f32 v119, v119, s46, -v44
    v_exp_f32 v116, v116
    v_exp_f32 v117, v117
    v_exp_f32 v118, v118
    v_exp_f32 v119, v119
    v_mul_f32 v56, v36, v56
    s_waitcnt lgkmcnt(15)
    v_mfma_f32_32x32x16_bf16 a[16:31], a[68:71], a[104:107], a[16:31]
    ds_read_b64_tr_b16 a[68:69], v29 offset:0
    ds_read_b64_tr_b16 a[70:71], v29 offset:1024
    v_mul_f32 v57, v36, v57
    v_mul_f32 v58, v36, v58
    v_mul_f32 v59, v36, v59
    v_mul_f32 v60, v36, v60
    v_mul_f32 v61, v36, v61
    v_mul_f32 v62, v36, v62
    s_waitcnt lgkmcnt(15)
    v_mfma_f32_32x32x16_bf16 a[32:47], a[72:75], a[104:107], a[32:47]
    ds_read_b64_tr_b16 a[72:73], v30 offset:0
    ds_read_b64_tr_b16 a[74:75], v30 offset:1024
    s_add_u32 m0, s74, 33792
    s_mov_b32 s47, 3178496
    buffer_load_dwordx4 v7, s[24:27], s47 offen lds
    v_mul_f32 v63, v36, v63
    v_cvt_pk_bf16_f32 v176, v112, v113
    v_cvt_pk_bf16_f32 v177, v114, v115
    v_fma_f32 v120, v120, s46, -v44
    v_fma_f32 v121, v121, s46, -v44
    v_fma_f32 v122, v122, s46, -v44
    s_waitcnt lgkmcnt(15)
    v_mfma_f32_32x32x16_bf16 a[48:63], a[76:79], a[104:107], a[48:63]
    ds_read_b64_tr_b16 a[76:77], v31 offset:0
    ds_read_b64_tr_b16 a[78:79], v31 offset:1024
    v_fma_f32 v123, v123, s46, -v44
    v_exp_f32 v120, v120
    v_exp_f32 v121, v121
    v_exp_f32 v122, v122
    v_exp_f32 v123, v123
    v_mul_f32 v64, v36, v64
    s_waitcnt lgkmcnt(15)
    v_mfma_f32_32x32x16_bf16 a[0:15], a[80:83], a[108:111], a[0:15]
    ds_read_b64_tr_b16 a[80:81], v28 offset:4096
    ds_read_b64_tr_b16 a[82:83], v28 offset:5120
    ds_read_b128 a[100:103], v253 offset:0
    s_add_u32 m0, s74, 40960
    s_mov_b32 s47, 768
    buffer_load_dwordx4 v32, s[32:35], s47 offen lds
    v_mul_f32 v65, v36, v65
    v_mul_f32 v66, v36, v66
    v_mul_f32 v67, v36, v67
    v_mul_f32 v68, v36, v68
    v_mul_f32 v69, v36, v69
    v_mul_f32 v70, v36, v70
    s_waitcnt lgkmcnt(15)
    v_mfma_f32_32x32x16_bf16 a[16:31], a[84:87], a[108:111], a[16:31]
    ds_read_b64_tr_b16 a[84:85], v29 offset:4096
    ds_read_b64_tr_b16 a[86:87], v29 offset:5120
    v_mul_f32 v71, v36, v71
    v_cvt_pk_bf16_f32 v178, v116, v117
    v_cvt_pk_bf16_f32 v179, v118, v119
    v_fma_f32 v124, v124, s46, -v44
    v_fma_f32 v125, v125, s46, -v44
    v_fma_f32 v126, v126, s46, -v44
    s_waitcnt lgkmcnt(15)
    v_mfma_f32_32x32x16_bf16 a[32:47], a[88:91], a[108:111], a[32:47]
    ds_read_b64_tr_b16 a[88:89], v30 offset:4096
    ds_read_b64_tr_b16 a[90:91], v30 offset:5120
    s_add_u32 m0, s74, 41984
    s_mov_b32 s47, 17152
    buffer_load_dwordx4 v32, s[32:35], s47 offen lds
    v_fma_f32 v127, v127, s46, -v44
    v_exp_f32 v124, v124
    v_exp_f32 v125, v125
    v_exp_f32 v126, v126
    v_exp_f32 v127, v127
    v_mul_f32 v72, v36, v72
    s_waitcnt lgkmcnt(15)
    v_mfma_f32_32x32x16_bf16 a[48:63], a[92:95], a[108:111], a[48:63]
    ds_read_b64_tr_b16 a[92:93], v31 offset:4096
    ds_read_b64_tr_b16 a[94:95], v31 offset:5120
    v_mul_f32 v73, v36, v73
    v_mul_f32 v74, v36, v74
    v_mul_f32 v75, v36, v75
    v_mul_f32 v76, v36, v76
    v_mul_f32 v77, v36, v77
    v_mul_f32 v78, v36, v78
    s_waitcnt vmcnt(20)
    s_barrier
    s_waitcnt lgkmcnt(15)
    v_mfma_f32_32x32x16_bf16 a[0:15], a[64:67], a[96:99], a[0:15]
    ds_read_b64_tr_b16 a[64:65], v28 offset:16384
    ds_read_b64_tr_b16 a[66:67], v28 offset:17408
    ds_read_b128 a[104:107], v252 offset:16384
    s_add_u32 m0, s74, 49152
    s_mov_b32 s47, 3407872
    buffer_load_dwordx4 v7, s[24:27], s47 offen lds
    v_mul_f32 v79, v36, v79
    v_cvt_pk_bf16_f32 v180, v120, v121
    v_cvt_pk_bf16_f32 v181, v122, v123
    v_fma_f32 v128, v128, s46, -v44
    v_fma_f32 v129, v129, s46, -v44
    v_fma_f32 v130, v130, s46, -v44
    s_waitcnt lgkmcnt(15)
    v_mfma_f32_32x32x16_bf16 a[16:31], a[68:71], a[96:99], a[16:31]
    ds_read_b64_tr_b16 a[68:69], v29 offset:16384
    ds_read_b64_tr_b16 a[70:71], v29 offset:17408
    v_fma_f32 v131, v131, s46, -v44
    v_exp_f32 v128, v128
    v_exp_f32 v129, v129
    v_exp_f32 v130, v130
    v_exp_f32 v131, v131
    v_mul_f32 v80, v36, v80
    s_waitcnt lgkmcnt(15)
    v_mfma_f32_32x32x16_bf16 a[32:47], a[72:75], a[96:99], a[32:47]
    ds_read_b64_tr_b16 a[72:73], v30 offset:16384
    ds_read_b64_tr_b16 a[74:75], v30 offset:17408
    s_add_u32 m0, s74, 50176
    s_mov_b32 s47, 3440640
    buffer_load_dwordx4 v7, s[24:27], s47 offen lds
    v_mul_f32 v81, v36, v81
    v_mul_f32 v82, v36, v82
    v_mul_f32 v83, v36, v83
    v_mul_f32 v84, v36, v84
    v_mul_f32 v85, v36, v85
    v_mul_f32 v86, v36, v86
    s_waitcnt lgkmcnt(15)
    v_mfma_f32_32x32x16_bf16 a[48:63], a[76:79], a[96:99], a[48:63]
    ds_read_b64_tr_b16 a[76:77], v31 offset:16384
    ds_read_b64_tr_b16 a[78:79], v31 offset:17408
    v_mul_f32 v87, v36, v87
    v_cvt_pk_bf16_f32 v182, v124, v125
    v_cvt_pk_bf16_f32 v183, v126, v127
    v_fma_f32 v132, v132, s46, -v44
    v_fma_f32 v133, v133, s46, -v44
    v_fma_f32 v134, v134, s46, -v44
    s_waitcnt lgkmcnt(15)
    v_mfma_f32_32x32x16_bf16 a[0:15], a[80:83], a[100:103], a[0:15]
    ds_read_b64_tr_b16 a[80:81], v28 offset:20480
    ds_read_b64_tr_b16 a[82:83], v28 offset:21504
    ds_read_b128 a[108:111], v253 offset:16384
    s_add_u32 m0, s74, 57344
    s_mov_b32 s47, 832
    buffer_load_dwordx4 v32, s[32:35], s47 offen lds
    v_fma_f32 v135, v135, s46, -v44
    v_exp_f32 v132, v132
    v_exp_f32 v133, v133
    v_exp_f32 v134, v134
    v_exp_f32 v135, v135
    v_mul_f32 v88, v36, v88
    s_waitcnt lgkmcnt(15)
    v_mfma_f32_32x32x16_bf16 a[16:31], a[84:87], a[100:103], a[16:31]
    ds_read_b64_tr_b16 a[84:85], v29 offset:20480
    ds_read_b64_tr_b16 a[86:87], v29 offset:21504
    v_mul_f32 v89, v36, v89
    v_mul_f32 v90, v36, v90
    v_mul_f32 v91, v36, v91
    v_mul_f32 v92, v36, v92
    v_mul_f32 v93, v36, v93
    v_mul_f32 v94, v36, v94
    s_waitcnt lgkmcnt(15)
    v_mfma_f32_32x32x16_bf16 a[32:47], a[88:91], a[100:103], a[32:47]
    ds_read_b64_tr_b16 a[88:89], v30 offset:20480
    ds_read_b64_tr_b16 a[90:91], v30 offset:21504
    s_add_u32 m0, s74, 58368
    s_mov_b32 s47, 17216
    buffer_load_dwordx4 v32, s[32:35], s47 offen lds
    v_mul_f32 v95, v36, v95
    v_cvt_pk_bf16_f32 v184, v128, v129
    v_cvt_pk_bf16_f32 v185, v130, v131
    v_fma_f32 v136, v136, s46, -v44
    v_fma_f32 v137, v137, s46, -v44
    v_fma_f32 v138, v138, s46, -v44
    s_waitcnt lgkmcnt(15)
    v_mfma_f32_32x32x16_bf16 a[48:63], a[92:95], a[100:103], a[48:63]
    ds_read_b64_tr_b16 a[92:93], v31 offset:20480
    ds_read_b64_tr_b16 a[94:95], v31 offset:21504
    v_fma_f32 v139, v139, s46, -v44
    v_exp_f32 v136, v136
    v_exp_f32 v137, v137
    v_exp_f32 v138, v138
    v_exp_f32 v139, v139
    v_mul_f32 v96, v36, v96
    s_waitcnt vmcnt(20)
    s_barrier
    s_waitcnt lgkmcnt(15)
    v_mfma_f32_32x32x16_bf16 a[0:15], a[64:67], a[104:107], a[0:15]
    ds_read_b64_tr_b16 a[64:65], v28 offset:32768
    ds_read_b64_tr_b16 a[66:67], v28 offset:33792
    s_add_u32 m0, s74, 65536
    s_mov_b32 s47, 3670016
    buffer_load_dwordx4 v7, s[24:27], s47 offen lds
    v_mul_f32 v97, v36, v97
    v_mul_f32 v98, v36, v98
    v_mul_f32 v99, v36, v99
    v_mul_f32 v100, v36, v100
    v_mul_f32 v101, v36, v101
    v_mul_f32 v102, v36, v102
    s_waitcnt lgkmcnt(15)
    v_mfma_f32_32x32x16_bf16 a[16:31], a[68:71], a[104:107], a[16:31]
    ds_read_b64_tr_b16 a[68:69], v29 offset:32768
    ds_read_b64_tr_b16 a[70:71], v29 offset:33792
    v_mul_f32 v103, v36, v103
    v_cvt_pk_bf16_f32 v186, v132, v133
    v_cvt_pk_bf16_f32 v187, v134, v135
    v_fma_f32 v140, v140, s46, -v44
    v_fma_f32 v141, v141, s46, -v44
    v_fma_f32 v142, v142, s46, -v44
    s_waitcnt lgkmcnt(15)
    v_mfma_f32_32x32x16_bf16 a[32:47], a[72:75], a[104:107], a[32:47]
    ds_read_b64_tr_b16 a[72:73], v30 offset:32768
    ds_read_b64_tr_b16 a[74:75], v30 offset:33792
    s_add_u32 m0, s74, 66560
    s_mov_b32 s47, 3702784
    buffer_load_dwordx4 v7, s[24:27], s47 offen lds
    v_fma_f32 v143, v143, s46, -v44
    v_exp_f32 v140, v140
    v_exp_f32 v141, v141
    v_exp_f32 v142, v142
    v_exp_f32 v143, v143
    v_mul_f32 v104, v36, v104
    s_waitcnt lgkmcnt(15)
    v_mfma_f32_32x32x16_bf16 a[48:63], a[76:79], a[104:107], a[48:63]
    ds_read_b64_tr_b16 a[76:77], v31 offset:32768
    ds_read_b64_tr_b16 a[78:79], v31 offset:33792
    v_mul_f32 v105, v36, v105
    v_mul_f32 v106, v36, v106
    v_mul_f32 v107, v36, v107
    v_mul_f32 v108, v36, v108
    v_mul_f32 v109, v36, v109
    v_mul_f32 v110, v36, v110
    s_waitcnt lgkmcnt(14)
    v_mfma_f32_32x32x16_bf16 a[0:15], a[80:83], a[108:111], a[0:15]
    ds_read_b64_tr_b16 a[80:81], v28 offset:36864
    ds_read_b64_tr_b16 a[82:83], v28 offset:37888
    s_add_u32 m0, s74, 73728
    s_mov_b32 s47, 896
    buffer_load_dwordx4 v32, s[32:35], s47 offen lds
    v_mul_f32 v111, v36, v111
    v_cvt_pk_bf16_f32 v188, v136, v137
    v_cvt_pk_bf16_f32 v189, v138, v139
    s_nop 0
    v_cvt_pk_bf16_f32 v190, v140, v141
    v_cvt_pk_bf16_f32 v191, v142, v143
    s_waitcnt lgkmcnt(14)
    v_mfma_f32_32x32x16_bf16 a[16:31], a[84:87], a[108:111], a[16:31]
    ds_read_b64_tr_b16 a[84:85], v29 offset:36864
    ds_read_b64_tr_b16 a[86:87], v29 offset:37888
    s_waitcnt lgkmcnt(14)
    v_mfma_f32_32x32x16_bf16 a[32:47], a[88:91], a[108:111], a[32:47]
    ds_read_b64_tr_b16 a[88:89], v30 offset:36864
    ds_read_b64_tr_b16 a[90:91], v30 offset:37888
    s_add_u32 m0, s74, 74752
    s_mov_b32 s47, 17280
    buffer_load_dwordx4 v32, s[32:35], s47 offen lds
    s_waitcnt lgkmcnt(14)
    v_mfma_f32_32x32x16_bf16 a[48:63], a[92:95], a[108:111], a[48:63]
    ds_read_b64_tr_b16 a[92:93], v31 offset:36864
    ds_read_b64_tr_b16 a[94:95], v31 offset:37888
    s_nop 1
    s_waitcnt vmcnt(20)
    s_barrier
    s_waitcnt lgkmcnt(14)
    v_mfma_f32_32x32x16_bf16 v[48:63], a[64:67], v[176:179], v[48:63]
    ds_read_b64_tr_b16 a[64:65], v28 offset:40960
    ds_read_b64_tr_b16 a[66:67], v28 offset:41984
    v_fma_f32 v144, v144, s46, -v44
    v_fma_f32 v145, v145, s46, -v44
    v_fma_f32 v146, v146, s46, -v44
    v_fma_f32 v147, v147, s46, -v44
    v_exp_f32 v144, v144
    v_exp_f32 v145, v145
    s_waitcnt lgkmcnt(14)
    v_mfma_f32_32x32x16_bf16 v[64:79], a[68:71], v[176:179], v[64:79]
    ds_read_b64_tr_b16 a[68:69], v29 offset:40960
    ds_read_b64_tr_b16 a[70:71], v29 offset:41984
    s_add_u32 m0, s74, 81920
    s_mov_b32 s47, 3932160
    buffer_load_dwordx4 v7, s[24:27], s47 offen lds
    v_exp_f32 v146, v146
    v_exp_f32 v147, v147
    v_fma_f32 v148, v148, s46, -v44
    v_fma_f32 v149, v149, s46, -v44
    v_fma_f32 v150, v150, s46, -v44
    v_fma_f32 v151, v151, s46, -v44
    s_waitcnt lgkmcnt(14)
    v_mfma_f32_32x32x16_bf16 v[80:95], a[72:75], v[176:179], v[80:95]
    ds_read_b64_tr_b16 a[72:73], v30 offset:40960
    ds_read_b64_tr_b16 a[74:75], v30 offset:41984
    v_exp_f32 v148, v148
    v_exp_f32 v149, v149
    v_exp_f32 v150, v150
    v_exp_f32 v151, v151
    v_cvt_pk_bf16_f32 v192, v144, v145
    v_cvt_pk_bf16_f32 v193, v146, v147
    s_waitcnt lgkmcnt(14)
    v_mfma_f32_32x32x16_bf16 v[96:111], a[76:79], v[176:179], v[96:111]
    ds_read_b64_tr_b16 a[76:77], v31 offset:40960
    ds_read_b64_tr_b16 a[78:79], v31 offset:41984
    v_fma_f32 v152, v152, s46, -v44
    v_fma_f32 v153, v153, s46, -v44
    v_fma_f32 v154, v154, s46, -v44
    v_fma_f32 v155, v155, s46, -v44
    v_exp_f32 v152, v152
    v_exp_f32 v153, v153
    s_waitcnt lgkmcnt(14)
    v_mfma_f32_32x32x16_bf16 v[48:63], a[80:83], v[180:183], v[48:63]
    ds_read_b64_tr_b16 a[80:81], v28 offset:45056
    ds_read_b64_tr_b16 a[82:83], v28 offset:46080
    v_exp_f32 v154, v154
    v_exp_f32 v155, v155
    v_cvt_pk_bf16_f32 v194, v148, v149
    v_cvt_pk_bf16_f32 v195, v150, v151
    v_fma_f32 v156, v156, s46, -v44
    v_fma_f32 v157, v157, s46, -v44
    s_waitcnt lgkmcnt(14)
    v_mfma_f32_32x32x16_bf16 v[64:79], a[84:87], v[180:183], v[64:79]
    ds_read_b64_tr_b16 a[84:85], v29 offset:45056
    ds_read_b64_tr_b16 a[86:87], v29 offset:46080
    s_add_u32 m0, s74, 82944
    s_mov_b32 s47, 3964928
    buffer_load_dwordx4 v7, s[24:27], s47 offen lds
    v_fma_f32 v158, v158, s46, -v44
    v_fma_f32 v159, v159, s46, -v44
    v_exp_f32 v156, v156
    v_exp_f32 v157, v157
    v_exp_f32 v158, v158
    v_exp_f32 v159, v159
    s_waitcnt lgkmcnt(14)
    v_mfma_f32_32x32x16_bf16 v[80:95], a[88:91], v[180:183], v[80:95]
    ds_read_b64_tr_b16 a[88:89], v30 offset:45056
    ds_read_b64_tr_b16 a[90:91], v30 offset:46080
    v_cvt_pk_bf16_f32 v196, v152, v153
    v_cvt_pk_bf16_f32 v197, v154, v155
    v_fma_f32 v160, v160, s46, -v44
    v_fma_f32 v161, v161, s46, -v44
    v_fma_f32 v162, v162, s46, -v44
    v_fma_f32 v163, v163, s46, -v44
    s_waitcnt lgkmcnt(14)
    v_mfma_f32_32x32x16_bf16 v[96:111], a[92:95], v[180:183], v[96:111]
    ds_read_b64_tr_b16 a[92:93], v31 offset:45056
    ds_read_b64_tr_b16 a[94:95], v31 offset:46080
    v_exp_f32 v160, v160
    v_exp_f32 v161, v161
    v_exp_f32 v162, v162
    v_exp_f32 v163, v163
    v_cvt_pk_bf16_f32 v198, v156, v157
    v_cvt_pk_bf16_f32 v199, v158, v159
    s_waitcnt lgkmcnt(14)
    v_mfma_f32_32x32x16_bf16 v[48:63], a[64:67], v[184:187], v[48:63]
    ds_read_b64_tr_b16 a[64:65], v28 offset:49152
    ds_read_b64_tr_b16 a[66:67], v28 offset:50176
    v_fma_f32 v164, v164, s46, -v44
    v_fma_f32 v165, v165, s46, -v44
    v_fma_f32 v166, v166, s46, -v44
    v_fma_f32 v167, v167, s46, -v44
    v_exp_f32 v164, v164
    v_exp_f32 v165, v165
    s_waitcnt lgkmcnt(14)
    v_mfma_f32_32x32x16_bf16 v[64:79], a[68:71], v[184:187], v[64:79]
    ds_read_b64_tr_b16 a[68:69], v29 offset:49152
    ds_read_b64_tr_b16 a[70:71], v29 offset:50176
    s_add_u32 m0, s74, 90112
    s_mov_b32 s47, 960
    buffer_load_dwordx4 v32, s[32:35], s47 offen lds
    v_exp_f32 v166, v166
    v_exp_f32 v167, v167
    v_cvt_pk_bf16_f32 v200, v160, v161
    v_cvt_pk_bf16_f32 v201, v162, v163
    v_fma_f32 v168, v168, s46, -v44
    v_fma_f32 v169, v169, s46, -v44
    s_waitcnt lgkmcnt(14)
    v_mfma_f32_32x32x16_bf16 v[80:95], a[72:75], v[184:187], v[80:95]
    ds_read_b64_tr_b16 a[72:73], v30 offset:49152
    ds_read_b64_tr_b16 a[74:75], v30 offset:50176
    v_fma_f32 v170, v170, s46, -v44
    v_fma_f32 v171, v171, s46, -v44
    v_exp_f32 v168, v168
    v_exp_f32 v169, v169
    v_exp_f32 v170, v170
    v_exp_f32 v171, v171
    s_waitcnt lgkmcnt(14)
    v_mfma_f32_32x32x16_bf16 v[96:111], a[76:79], v[184:187], v[96:111]
    ds_read_b64_tr_b16 a[76:77], v31 offset:49152
    ds_read_b64_tr_b16 a[78:79], v31 offset:50176
    v_cvt_pk_bf16_f32 v202, v164, v165
    v_cvt_pk_bf16_f32 v203, v166, v167
    v_fma_f32 v172, v172, s46, -v44
    v_fma_f32 v173, v173, s46, -v44
    v_fma_f32 v174, v174, s46, -v44
    v_fma_f32 v175, v175, s46, -v44
    s_waitcnt lgkmcnt(14)
    v_mfma_f32_32x32x16_bf16 v[48:63], a[80:83], v[188:191], v[48:63]
    ds_read_b64_tr_b16 a[80:81], v28 offset:53248
    ds_read_b64_tr_b16 a[82:83], v28 offset:54272
    v_exp_f32 v172, v172
    v_exp_f32 v173, v173
    v_exp_f32 v174, v174
    v_exp_f32 v175, v175
    v_cvt_pk_bf16_f32 v204, v168, v169
    v_cvt_pk_bf16_f32 v205, v170, v171
    s_waitcnt lgkmcnt(14)
    v_mfma_f32_32x32x16_bf16 v[64:79], a[84:87], v[188:191], v[64:79]
    ds_read_b64_tr_b16 a[84:85], v29 offset:53248
    ds_read_b64_tr_b16 a[86:87], v29 offset:54272
    s_add_u32 m0, s74, 91136
    s_mov_b32 s47, 17344
    buffer_load_dwordx4 v32, s[32:35], s47 offen lds
    s_nop 0
    v_cvt_pk_bf16_f32 v206, v172, v173
    v_cvt_pk_bf16_f32 v207, v174, v175
    s_waitcnt lgkmcnt(14)
    v_mfma_f32_32x32x16_bf16 v[80:95], a[88:91], v[188:191], v[80:95]
    ds_read_b64_tr_b16 a[88:89], v30 offset:53248
    ds_read_b64_tr_b16 a[90:91], v30 offset:54272
    s_waitcnt lgkmcnt(14)
    v_mfma_f32_32x32x16_bf16 v[96:111], a[92:95], v[188:191], v[96:111]
    ds_read_b64_tr_b16 a[92:93], v31 offset:53248
    ds_read_b64_tr_b16 a[94:95], v31 offset:54272
    s_nop 1
    s_waitcnt vmcnt(20)
    s_barrier
    s_waitcnt lgkmcnt(14)
    v_mfma_f32_32x32x16_bf16 v[48:63], a[64:67], v[192:195], v[48:63]
    ds_read_b64_tr_b16 a[64:65], v28 offset:57344
    ds_read_b64_tr_b16 a[66:67], v28 offset:58368
    v_add_f32 v40, v112, v113
    v_add_f32 v41, v128, v129
    v_add_f32 v42, v144, v145
    v_add_f32 v43, v160, v161
    v_add_f32 v40, v40, v114
    s_waitcnt lgkmcnt(14)
    v_mfma_f32_32x32x16_bf16 v[64:79], a[68:71], v[192:195], v[64:79]
    ds_read_b64_tr_b16 a[68:69], v29 offset:57344
    ds_read_b64_tr_b16 a[70:71], v29 offset:58368
    s_add_u32 m0, s45, 98304
    s_mov_b32 s47, 98304
    buffer_load_dwordx4 v6, s[12:15], s47 offen offset:0 nt lds
    v_add_f32 v41, v41, v130
    v_add_f32 v42, v42, v146
    v_add_f32 v43, v43, v162
    v_add_f32 v40, v40, v115
    v_add_f32 v41, v41, v131
    s_waitcnt lgkmcnt(14)
    v_mfma_f32_32x32x16_bf16 v[80:95], a[72:75], v[192:195], v[80:95]
    ds_read_b64_tr_b16 a[72:73], v30 offset:57344
    ds_read_b64_tr_b16 a[74:75], v30 offset:58368
    v_add_f32 v42, v42, v147
    v_add_f32 v43, v43, v163
    v_add_f32 v40, v40, v116
    v_add_f32 v41, v41, v132
    v_add_f32 v42, v42, v148
    s_waitcnt lgkmcnt(14)
    v_mfma_f32_32x32x16_bf16 v[96:111], a[76:79], v[192:195], v[96:111]
    ds_read_b64_tr_b16 a[76:77], v31 offset:57344
    ds_read_b64_tr_b16 a[78:79], v31 offset:58368
    v_add_f32 v43, v43, v164
    v_add_f32 v40, v40, v117
    v_add_f32 v41, v41, v133
    v_add_f32 v42, v42, v149
    v_add_f32 v43, v43, v165
    s_waitcnt lgkmcnt(14)
    v_mfma_f32_32x32x16_bf16 v[48:63], a[80:83], v[196:199], v[48:63]
    ds_read_b64_tr_b16 a[80:81], v28 offset:61440
    ds_read_b64_tr_b16 a[82:83], v28 offset:62464
    v_add_f32 v40, v40, v118
    v_add_f32 v41, v41, v134
    v_add_f32 v42, v42, v150
    v_add_f32 v43, v43, v166
    v_add_f32 v40, v40, v119
    s_waitcnt lgkmcnt(14)
    v_mfma_f32_32x32x16_bf16 v[64:79], a[84:87], v[196:199], v[64:79]
    ds_read_b64_tr_b16 a[84:85], v29 offset:61440
    ds_read_b64_tr_b16 a[86:87], v29 offset:62464
    s_add_u32 m0, s45, 98304
    s_mov_b32 s47, 98304
    buffer_load_dwordx4 v6, s[12:15], s47 offen offset:1024 nt lds
    v_add_f32 v41, v41, v135
    v_add_f32 v42, v42, v151
    v_add_f32 v43, v43, v167
    v_add_f32 v40, v40, v120
    v_add_f32 v41, v41, v136
    s_waitcnt lgkmcnt(14)
    v_mfma_f32_32x32x16_bf16 v[80:95], a[88:91], v[196:199], v[80:95]
    ds_read_b64_tr_b16 a[88:89], v30 offset:61440
    ds_read_b64_tr_b16 a[90:91], v30 offset:62464
    v_add_f32 v42, v42, v152
    v_add_f32 v43, v43, v168
    v_add_f32 v40, v40, v121
    v_add_f32 v41, v41, v137
    v_add_f32 v42, v42, v153
    s_waitcnt lgkmcnt(14)
    v_mfma_f32_32x32x16_bf16 v[96:111], a[92:95], v[196:199], v[96:111]
    ds_read_b64_tr_b16 a[92:93], v31 offset:61440
    ds_read_b64_tr_b16 a[94:95], v31 offset:62464
    v_add_f32 v43, v43, v169
    v_add_f32 v40, v40, v122
    v_add_f32 v41, v41, v138
    v_add_f32 v42, v42, v154
    v_add_f32 v43, v43, v170
    s_waitcnt lgkmcnt(14)
    v_mfma_f32_32x32x16_bf16 v[48:63], a[64:67], v[200:203], v[48:63]
    ds_read_b128 a[64:67], v8 offset:0
    v_add_f32 v40, v40, v123
    v_add_f32 v41, v41, v139
    v_add_f32 v42, v42, v155
    v_add_f32 v43, v43, v171
    v_add_f32 v40, v40, v124
    s_waitcnt lgkmcnt(13)
    v_mfma_f32_32x32x16_bf16 v[64:79], a[68:71], v[200:203], v[64:79]
    ds_read_b128 a[68:71], v9 offset:0
    s_add_u32 m0, s45, 98304
    s_mov_b32 s47, 98304
    buffer_load_dwordx4 v6, s[12:15], s47 offen offset:2048 nt lds
    v_add_f32 v41, v41, v140
    v_add_f32 v42, v42, v156
    v_add_f32 v43, v43, v172
    v_add_f32 v40, v40, v125
    v_add_f32 v41, v41, v141
    s_waitcnt lgkmcnt(12)
    v_mfma_f32_32x32x16_bf16 v[80:95], a[72:75], v[200:203], v[80:95]
    ds_read_b128 a[72:75], v10 offset:0
    v_add_f32 v42, v42, v157
    v_add_f32 v43, v43, v173
    v_add_f32 v40, v40, v126
    v_add_f32 v41, v41, v142
    v_add_f32 v42, v42, v158
    s_waitcnt lgkmcnt(11)
    v_mfma_f32_32x32x16_bf16 v[96:111], a[76:79], v[200:203], v[96:111]
    ds_read_b128 a[76:79], v11 offset:0
    v_add_f32 v43, v43, v174
    v_add_f32 v40, v40, v127
    v_add_f32 v41, v41, v143
    v_add_f32 v42, v42, v159
    v_add_f32 v43, v43, v175
    s_waitcnt lgkmcnt(10)
    v_mfma_f32_32x32x16_bf16 v[48:63], a[80:83], v[204:207], v[48:63]
    ds_read_b128 a[80:83], v12 offset:0
    v_add_f32 v40, v40, v41
    v_add_f32 v42, v42, v43
    v_add_f32 v40, v40, v42
    v_fma_f32 v35, v35, v36, v40
    s_waitcnt lgkmcnt(9)
    v_mfma_f32_32x32x16_bf16 v[64:79], a[84:87], v[204:207], v[64:79]
    ds_read_b128 a[84:87], v13 offset:0
    s_add_u32 m0, s45, 98304
    s_mov_b32 s47, 98304
    buffer_load_dwordx4 v6, s[12:15], s47 offen offset:3072 nt lds
    s_waitcnt lgkmcnt(8)
    v_mfma_f32_32x32x16_bf16 v[80:95], a[88:91], v[204:207], v[80:95]
    ds_read_b128 a[88:91], v14 offset:0
    s_waitcnt lgkmcnt(7)
    v_mfma_f32_32x32x16_bf16 v[96:111], a[92:95], v[204:207], v[96:111]
    ds_read_b128 a[92:95], v15 offset:0
    s_nop 1
    s_waitcnt vmcnt(20)
    s_barrier
    s_waitcnt lgkmcnt(7)
    v_mfma_f32_32x32x16_bf16 v[112:127], a[64:67], v[208:211], 0
    ds_read_b128 a[64:67], v8 offset:8192
    s_waitcnt lgkmcnt(7)
    v_mfma_f32_32x32x16_bf16 v[112:127], a[68:71], v[212:215], v[112:127]
    ds_read_b128 a[68:71], v9 offset:8192
    s_add_u32 m0, s45, 114688
    s_mov_b32 s47, 114688
    buffer_load_dwordx4 v6, s[12:15], s47 offen offset:0 nt lds
    s_waitcnt lgkmcnt(7)
    v_mfma_f32_32x32x16_bf16 v[112:127], a[72:75], v[216:219], v[112:127]
    ds_read_b128 a[72:75], v10 offset:8192
    s_waitcnt lgkmcnt(7)
    v_mfma_f32_32x32x16_bf16 v[112:127], a[76:79], v[220:223], v[112:127]
    ds_read_b128 a[76:79], v11 offset:8192
    s_waitcnt lgkmcnt(7)
    v_mfma_f32_32x32x16_bf16 v[112:127], a[80:83], v[224:227], v[112:127]
    ds_read_b128 a[80:83], v12 offset:8192
    s_waitcnt lgkmcnt(7)
    v_mfma_f32_32x32x16_bf16 v[112:127], a[84:87], v[228:231], v[112:127]
    ds_read_b128 a[84:87], v13 offset:8192
    s_add_u32 m0, s45, 114688
    s_mov_b32 s47, 114688
    buffer_load_dwordx4 v6, s[12:15], s47 offen offset:1024 nt lds
    s_waitcnt lgkmcnt(7)
    v_mfma_f32_32x32x16_bf16 v[112:127], a[88:91], v[232:235], v[112:127]
    ds_read_b128 a[88:91], v14 offset:8192
    s_waitcnt lgkmcnt(7)
    v_mfma_f32_32x32x16_bf16 v[112:127], a[92:95], v[236:239], v[112:127]
    ds_read_b128 a[92:95], v15 offset:8192
    s_waitcnt lgkmcnt(7)
    v_mfma_f32_32x32x16_bf16 v[128:143], a[64:67], v[208:211], 0
    ds_read_b128 a[64:67], v8 offset:16384
    s_waitcnt lgkmcnt(7)
    v_mfma_f32_32x32x16_bf16 v[128:143], a[68:71], v[212:215], v[128:143]
    ds_read_b128 a[68:71], v9 offset:16384
    s_add_u32 m0, s45, 114688
    s_mov_b32 s47, 114688
    buffer_load_dwordx4 v6, s[12:15], s47 offen offset:2048 nt lds
    s_waitcnt lgkmcnt(7)
    v_mfma_f32_32x32x16_bf16 v[128:143], a[72:75], v[216:219], v[128:143]
    ds_read_b128 a[72:75], v10 offset:16384
    s_waitcnt lgkmcnt(7)
    v_mfma_f32_32x32x16_bf16 v[128:143], a[76:79], v[220:223], v[128:143]
    ds_read_b128 a[76:79], v11 offset:16384
    s_waitcnt lgkmcnt(7)
    v_mfma_f32_32x32x16_bf16 v[128:143], a[80:83], v[224:227], v[128:143]
    ds_read_b128 a[80:83], v12 offset:16384
    s_waitcnt lgkmcnt(7)
    v_mfma_f32_32x32x16_bf16 v[128:143], a[84:87], v[228:231], v[128:143]
    ds_read_b128 a[84:87], v13 offset:16384
    s_add_u32 m0, s45, 114688
    s_mov_b32 s47, 114688
    buffer_load_dwordx4 v6, s[12:15], s47 offen offset:3072 nt lds
    s_waitcnt lgkmcnt(7)
    v_mfma_f32_32x32x16_bf16 v[128:143], a[88:91], v[232:235], v[128:143]
    ds_read_b128 a[88:91], v14 offset:16384
    s_waitcnt lgkmcnt(7)
    v_mfma_f32_32x32x16_bf16 v[128:143], a[92:95], v[236:239], v[128:143]
    ds_read_b128 a[92:95], v15 offset:16384
    s_nop 1
    s_waitcnt vmcnt(20)
    s_barrier
    s_waitcnt lgkmcnt(7)
    v_mfma_f32_32x32x16_bf16 v[144:159], a[64:67], v[208:211], 0
    ds_read_b128 a[64:67], v8 offset:24576
    s_nop 7
    v_max3_f32 v40, v112, v113, v114
    s_waitcnt lgkmcnt(7)
    v_mfma_f32_32x32x16_bf16 v[144:159], a[68:71], v[212:215], v[144:159]
    ds_read_b128 a[68:71], v9 offset:24576
    s_add_u32 m0, s45, 0
    s_mov_b32 s47, 0
    buffer_load_dwordx4 v2, s[16:19], s47 offen offset:0 nt lds
    v_max3_f32 v41, v128, v129, v130
    v_max3_f32 v40, v40, v115, v116
    s_waitcnt lgkmcnt(7)
    v_mfma_f32_32x32x16_bf16 v[144:159], a[72:75], v[216:219], v[144:159]
    ds_read_b128 a[72:75], v10 offset:24576
    v_max3_f32 v41, v41, v131, v132
    v_max3_f32 v40, v40, v117, v118
    s_waitcnt lgkmcnt(7)
    v_mfma_f32_32x32x16_bf16 v[144:159], a[76:79], v[220:223], v[144:159]
    ds_read_b128 a[76:79], v11 offset:24576
    v_max3_f32 v41, v41, v133, v134
    v_max3_f32 v40, v40, v119, v120
    s_waitcnt lgkmcnt(7)
    v_mfma_f32_32x32x16_bf16 v[144:159], a[80:83], v[224:227], v[144:159]
    ds_read_b128 a[80:83], v12 offset:24576
    v_max3_f32 v41, v41, v135, v136
    v_max3_f32 v40, v40, v121, v122
    s_waitcnt lgkmcnt(7)
    v_mfma_f32_32x32x16_bf16 v[144:159], a[84:87], v[228:231], v[144:159]
    ds_read_b128 a[84:87], v13 offset:24576
    s_add_u32 m0, s45, 0
    s_mov_b32 s47, 0
    buffer_load_dwordx4 v3, s[16:19], s47 offen offset:1024 nt lds
    v_max3_f32 v41, v41, v137, v138
    v_max3_f32 v40, v40, v123, v124
    s_waitcnt lgkmcnt(7)
    v_mfma_f32_32x32x16_bf16 v[144:159], a[88:91], v[232:235], v[144:159]
    ds_read_b128 a[88:91], v14 offset:24576
    v_max3_f32 v41, v41, v139, v140
    v_max3_f32 v40, v40, v125, v126
    s_waitcnt lgkmcnt(7)
    v_mfma_f32_32x32x16_bf16 v[144:159], a[92:95], v[236:239], v[144:159]
    ds_read_b128 a[92:95], v15 offset:24576
    v_max3_f32 v41, v41, v141, v142
    v_max_f32 v40, v40, v127
    s_waitcnt lgkmcnt(7)
    v_mfma_f32_32x32x16_bf16 v[160:175], a[64:67], v[208:211], 0
    ds_read_b64_tr_b16 a[64:65], v24 offset:32768
    ds_read_b64_tr_b16 a[66:67], v24 offset:33792
    ds_read_b128 a[96:99], v250 offset:32768
    v_max_f32 v41, v41, v143
    s_waitcnt lgkmcnt(9)
    v_mfma_f32_32x32x16_bf16 v[160:175], a[68:71], v[212:215], v[160:175]
    ds_read_b64_tr_b16 a[68:69], v25 offset:32768
    ds_read_b64_tr_b16 a[70:71], v25 offset:33792
    s_add_u32 m0, s45, 0
    s_mov_b32 s47, 0
    buffer_load_dwordx4 v4, s[16:19], s47 offen offset:2048 nt lds
    s_waitcnt lgkmcnt(10)
    v_mfma_f32_32x32x16_bf16 v[160:175], a[72:75], v[216:219], v[160:175]
    ds_read_b64_tr_b16 a[72:73], v26 offset:32768
    ds_read_b64_tr_b16 a[74:75], v26 offset:33792
    s_waitcnt lgkmcnt(11)
    v_mfma_f32_32x32x16_bf16 v[160:175], a[76:79], v[220:223], v[160:175]
    ds_read_b64_tr_b16 a[76:77], v27 offset:32768
    ds_read_b64_tr_b16 a[78:79], v27 offset:33792
    s_waitcnt lgkmcnt(12)
    v_mfma_f32_32x32x16_bf16 v[160:175], a[80:83], v[224:227], v[160:175]
    ds_read_b64_tr_b16 a[80:81], v24 offset:36864
    ds_read_b64_tr_b16 a[82:83], v24 offset:37888
    ds_read_b128 a[100:103], v251 offset:32768
    s_waitcnt lgkmcnt(14)
    v_mfma_f32_32x32x16_bf16 v[160:175], a[84:87], v[228:231], v[160:175]
    ds_read_b64_tr_b16 a[84:85], v25 offset:36864
    ds_read_b64_tr_b16 a[86:87], v25 offset:37888
    s_add_u32 m0, s45, 0
    s_mov_b32 s47, 0
    buffer_load_dwordx4 v5, s[16:19], s47 offen offset:3072 nt lds
    s_waitcnt lgkmcnt(15)
    v_mfma_f32_32x32x16_bf16 v[160:175], a[88:91], v[232:235], v[160:175]
    ds_read_b64_tr_b16 a[88:89], v26 offset:36864
    ds_read_b64_tr_b16 a[90:91], v26 offset:37888
    s_waitcnt lgkmcnt(15)
    v_mfma_f32_32x32x16_bf16 v[160:175], a[92:95], v[236:239], v[160:175]
    ds_read_b64_tr_b16 a[92:93], v27 offset:36864
    ds_read_b64_tr_b16 a[94:95], v27 offset:37888
    s_nop 1
    s_waitcnt vmcnt(20)
    s_barrier
    s_waitcnt lgkmcnt(15)
    v_mfma_f32_32x32x16_bf16 a[0:15], a[64:67], a[96:99], a[0:15]
    ds_read_b64_tr_b16 a[64:65], v24 offset:49152
    ds_read_b64_tr_b16 a[66:67], v24 offset:50176
    ds_read_b128 a[104:107], v250 offset:49152
    s_add_u32 m0, s45, 16384
    s_mov_b32 s47, 16384
    buffer_load_dwordx4 v2, s[16:19], s47 offen offset:0 nt lds
    s_nop 7
    v_max3_f32 v42, v144, v145, v146
    v_max3_f32 v43, v160, v161, v162
    v_max3_f32 v42, v42, v147, v148
    v_max3_f32 v43, v43, v163, v164
    v_max3_f32 v42, v42, v149, v150
    s_waitcnt lgkmcnt(15)
    v_mfma_f32_32x32x16_bf16 a[16:31], a[68:71], a[96:99], a[16:31]
    ds_read_b64_tr_b16 a[68:69], v25 offset:49152
    ds_read_b64_tr_b16 a[70:71], v25 offset:50176
    v_max3_f32 v43, v43, v165, v166
    v_max3_f32 v42, v42, v151, v152
    v_max3_f32 v43, v43, v167, v168
    v_max3_f32 v42, v42, v153, v154
    v_max3_f32 v43, v43, v169, v170
    v_max3_f32 v42, v42, v155, v156
    s_waitcnt lgkmcnt(15)
    v_mfma_f32_32x32x16_bf16 a[32:47], a[72:75], a[96:99], a[32:47]
    ds_read_b64_tr_b16 a[72:73], v26 offset:49152
    ds_read_b64_tr_b16 a[74:75], v26 offset:50176
    s_add_u32 m0, s45, 16384
    s_mov_b32 s47, 16384
    buffer_load_dwordx4 v3, s[16:19], s47 offen offset:1024 nt lds
    v_max3_f32 v43, v43, v171, v172
    v_max3_f32 v42, v42, v157, v158
    v_max3_f32 v43, v43, v173, v174
    v_max_f32 v42, v42, v159
    v_max_f32 v43, v43, v175
    v_max3_f32 v40, v40, v41, v42
    s_waitcnt lgkmcnt(15)
    v_mfma_f32_32x32x16_bf16 a[48:63], a[76:79], a[96:99], a[48:63]
    ds_read_b64_tr_b16 a[76:77], v27 offset:49152
    ds_read_b64_tr_b16 a[78:79], v27 offset:50176
    v_max_f32 v40, v40, v43
    v_mov_b32 v41, v40
    s_nop 1
    v_permlane32_swap_b32 v40, v41
    s_nop 1
    v_max3_f32 v42, v40, v41, v34
    s_waitcnt lgkmcnt(15)
    v_mfma_f32_32x32x16_bf16 a[0:15], a[80:83], a[100:103], a[0:15]
    ds_read_b64_tr_b16 a[80:81], v24 offset:53248
    ds_read_b64_tr_b16 a[82:83], v24 offset:54272
    ds_read_b128 a[108:111], v251 offset:49152
    s_add_u32 m0, s45, 16384
    s_mov_b32 s47, 16384
    buffer_load_dwordx4 v4, s[16:19], s47 offen offset:2048 nt lds
    v_sub_f32 v43, v34, v42
    v_mul_f32 v43, s46, v43
    v_exp_f32 v36, v43
    v_mov_b32 v34, v42
    v_mul_f32 v44, s46, v34
    v_fma_f32 v112, v112, s46, -v44
    s_waitcnt lgkmcnt(15)
    v_mfma_f32_32x32x16_bf16 a[16:31], a[84:87], a[100:103], a[16:31]
    ds_read_b64_tr_b16 a[84:85], v25 offset:53248
    ds_read_b64_tr_b16 a[86:87], v25 offset:54272
    v_fma_f32 v113, v113, s46, -v44
    v_fma_f32 v114, v114, s46, -v44
    v_fma_f32 v115, v115, s46, -v44
    v_exp_f32 v112, v112
    v_exp_f32 v113, v113
    v_exp_f32 v114, v114
    s_waitcnt lgkmcnt(15)
    v_mfma_f32_32x32x16_bf16 a[32:47], a[88:91], a[100:103], a[32:47]
    ds_read_b64_tr_b16 a[88:89], v26 offset:53248
    ds_read_b64_tr_b16 a[90:91], v26 offset:54272
    s_add_u32 m0, s45, 16384
    s_mov_b32 s47, 16384
    buffer_load_dwordx4 v5, s[16:19], s47 offen offset:3072 nt lds
    v_exp_f32 v115, v115
    v_mul_f32 v48, v36, v48
    v_mul_f32 v49, v36, v49
    v_mul_f32 v50, v36, v50
    v_mul_f32 v51, v36, v51
    v_mul_f32 v52, v36, v52
    s_waitcnt lgkmcnt(15)
    v_mfma_f32_32x32x16_bf16 a[48:63], a[92:95], a[100:103], a[48:63]
    ds_read_b64_tr_b16 a[92:93], v27 offset:53248
    ds_read_b64_tr_b16 a[94:95], v27 offset:54272
    v_mul_f32 v53, v36, v53
    v_mul_f32 v54, v36, v54
    v_mul_f32 v55, v36, v55
    v_fma_f32 v116, v116, s46, -v44
    v_fma_f32 v117, v117, s46, -v44
    v_fma_f32 v118, v118, s46, -v44
    s_waitcnt vmcnt(20)
    s_barrier
    s_waitcnt lgkmcnt(15)
    v_mfma_f32_32x32x16_bf16 a[0:15], a[64:67], a[104:107], a[0:15]
    ds_read_b64_tr_b16 a[64:65], v28 offset:0
    ds_read_b64_tr_b16 a[66:67], v28 offset:1024
    ds_read_b128 a[96:99], v252 offset:0
    s_add_u32 m0, s74, 32768
    s_mov_b32 s47, 0
    buffer_load_dwordx4 v7, s[28:31], s47 offen lds
    v_fma_f32 v119, v119, s46, -v44
    v_exp_f32 v116, v116
    v_exp_f32 v117, v117
    v_exp_f32 v118, v118
    v_exp_f32 v119, v119
    v_mul_f32 v56, v36, v56
    s_waitcnt lgkmcnt(15)
    v_mfma_f32_32x32x16_bf16 a[16:31], a[68:71], a[104:107], a[16:31]
    ds_read_b64_tr_b16 a[68:69], v29 offset:0
    ds_read_b64_tr_b16 a[70:71], v29 offset:1024
    v_mul_f32 v57, v36, v57
    v_mul_f32 v58, v36, v58
    v_mul_f32 v59, v36, v59
    v_mul_f32 v60, v36, v60
    v_mul_f32 v61, v36, v61
    v_mul_f32 v62, v36, v62
    s_waitcnt lgkmcnt(15)
    v_mfma_f32_32x32x16_bf16 a[32:47], a[72:75], a[104:107], a[32:47]
    ds_read_b64_tr_b16 a[72:73], v30 offset:0
    ds_read_b64_tr_b16 a[74:75], v30 offset:1024
    s_add_u32 m0, s74, 33792
    s_mov_b32 s47, 32768
    buffer_load_dwordx4 v7, s[28:31], s47 offen lds
    v_mul_f32 v63, v36, v63
    v_cvt_pk_bf16_f32 v176, v112, v113
    v_cvt_pk_bf16_f32 v177, v114, v115
    v_fma_f32 v120, v120, s46, -v44
    v_fma_f32 v121, v121, s46, -v44
    v_fma_f32 v122, v122, s46, -v44
    s_waitcnt lgkmcnt(15)
    v_mfma_f32_32x32x16_bf16 a[48:63], a[76:79], a[104:107], a[48:63]
    ds_read_b64_tr_b16 a[76:77], v31 offset:0
    ds_read_b64_tr_b16 a[78:79], v31 offset:1024
    v_fma_f32 v123, v123, s46, -v44
    v_exp_f32 v120, v120
    v_exp_f32 v121, v121
    v_exp_f32 v122, v122
    v_exp_f32 v123, v123
    v_mul_f32 v64, v36, v64
    s_waitcnt lgkmcnt(15)
    v_mfma_f32_32x32x16_bf16 a[0:15], a[80:83], a[108:111], a[0:15]
    ds_read_b64_tr_b16 a[80:81], v28 offset:4096
    ds_read_b64_tr_b16 a[82:83], v28 offset:5120
    ds_read_b128 a[100:103], v253 offset:0
    s_add_u32 m0, s74, 40960
    s_mov_b32 s47, 0
    buffer_load_dwordx4 v32, s[36:39], s47 offen lds
    v_mul_f32 v65, v36, v65
    v_mul_f32 v66, v36, v66
    v_mul_f32 v67, v36, v67
    v_mul_f32 v68, v36, v68
    v_mul_f32 v69, v36, v69
    v_mul_f32 v70, v36, v70
    s_waitcnt lgkmcnt(15)
    v_mfma_f32_32x32x16_bf16 a[16:31], a[84:87], a[108:111], a[16:31]
    ds_read_b64_tr_b16 a[84:85], v29 offset:4096
    ds_read_b64_tr_b16 a[86:87], v29 offset:5120
    v_mul_f32 v71, v36, v71
    v_cvt_pk_bf16_f32 v178, v116, v117
    v_cvt_pk_bf16_f32 v179, v118, v119
    v_fma_f32 v124, v124, s46, -v44
    v_fma_f32 v125, v125, s46, -v44
    v_fma_f32 v126, v126, s46, -v44
    s_waitcnt lgkmcnt(15)
    v_mfma_f32_32x32x16_bf16 a[32:47], a[88:91], a[108:111], a[32:47]
    ds_read_b64_tr_b16 a[88:89], v30 offset:4096
    ds_read_b64_tr_b16 a[90:91], v30 offset:5120
    s_add_u32 m0, s74, 41984
    s_mov_b32 s47, 16384
    buffer_load_dwordx4 v32, s[36:39], s47 offen lds
    v_fma_f32 v127, v127, s46, -v44
    v_exp_f32 v124, v124
    v_exp_f32 v125, v125
    v_exp_f32 v126, v126
    v_exp_f32 v127, v127
    v_mul_f32 v72, v36, v72
    s_waitcnt lgkmcnt(15)
    v_mfma_f32_32x32x16_bf16 a[48:63], a[92:95], a[108:111], a[48:63]
    ds_read_b64_tr_b16 a[92:93], v31 offset:4096
    ds_read_b64_tr_b16 a[94:95], v31 offset:5120
    v_mul_f32 v73, v36, v73
    v_mul_f32 v74, v36, v74
    v_mul_f32 v75, v36, v75
    v_mul_f32 v76, v36, v76
    v_mul_f32 v77, v36, v77
    v_mul_f32 v78, v36, v78
    s_waitcnt vmcnt(20)
    s_barrier
    s_waitcnt lgkmcnt(15)
    v_mfma_f32_32x32x16_bf16 a[0:15], a[64:67], a[96:99], a[0:15]
    ds_read_b64_tr_b16 a[64:65], v28 offset:16384
    ds_read_b64_tr_b16 a[66:67], v28 offset:17408
    ds_read_b128 a[104:107], v252 offset:16384
    s_add_u32 m0, s74, 49152
    s_mov_b32 s47, 262144
    buffer_load_dwordx4 v7, s[28:31], s47 offen lds
    v_mul_f32 v79, v36, v79
    v_cvt_pk_bf16_f32 v180, v120, v121
    v_cvt_pk_bf16_f32 v181, v122, v123
    v_fma_f32 v128, v128, s46, -v44
    v_fma_f32 v129, v129, s46, -v44
    v_fma_f32 v130, v130, s46, -v44
    s_waitcnt lgkmcnt(15)
    v_mfma_f32_32x32x16_bf16 a[16:31], a[68:71], a[96:99], a[16:31]
    ds_read_b64_tr_b16 a[68:69], v29 offset:16384
    ds_read_b64_tr_b16 a[70:71], v29 offset:17408
    v_fma_f32 v131, v131, s46, -v44
    v_exp_f32 v128, v128
    v_exp_f32 v129, v129
    v_exp_f32 v130, v130
    v_exp_f32 v131, v131
    v_mul_f32 v80, v36, v80
    s_waitcnt lgkmcnt(15)
    v_mfma_f32_32x32x16_bf16 a[32:47], a[72:75], a[96:99], a[32:47]
    ds_read_b64_tr_b16 a[72:73], v30 offset:16384
    ds_read_b64_tr_b16 a[74:75], v30 offset:17408
    s_add_u32 m0, s74, 50176
    s_mov_b32 s47, 294912
    buffer_load_dwordx4 v7, s[28:31], s47 offen lds
    v_mul_f32 v81, v36, v81
    v_mul_f32 v82, v36, v82
    v_mul_f32 v83, v36, v83
    v_mul_f32 v84, v36, v84
    v_mul_f32 v85, v36, v85
    v_mul_f32 v86, v36, v86
    s_waitcnt lgkmcnt(15)
    v_mfma_f32_32x32x16_bf16 a[48:63], a[76:79], a[96:99], a[48:63]
    ds_read_b64_tr_b16 a[76:77], v31 offset:16384
    ds_read_b64_tr_b16 a[78:79], v31 offset:17408
    v_mul_f32 v87, v36, v87
    v_cvt_pk_bf16_f32 v182, v124, v125
    v_cvt_pk_bf16_f32 v183, v126, v127
    v_fma_f32 v132, v132, s46, -v44
    v_fma_f32 v133, v133, s46, -v44
    v_fma_f32 v134, v134, s46, -v44
    s_waitcnt lgkmcnt(15)
    v_mfma_f32_32x32x16_bf16 a[0:15], a[80:83], a[100:103], a[0:15]
    ds_read_b64_tr_b16 a[80:81], v28 offset:20480
    ds_read_b64_tr_b16 a[82:83], v28 offset:21504
    ds_read_b128 a[108:111], v253 offset:16384
    s_add_u32 m0, s74, 57344
    s_mov_b32 s47, 64
    buffer_load_dwordx4 v32, s[36:39], s47 offen lds
    v_fma_f32 v135, v135, s46, -v44
    v_exp_f32 v132, v132
    v_exp_f32 v133, v133
    v_exp_f32 v134, v134
    v_exp_f32 v135, v135
    v_mul_f32 v88, v36, v88
    s_waitcnt lgkmcnt(15)
    v_mfma_f32_32x32x16_bf16 a[16:31], a[84:87], a[100:103], a[16:31]
    ds_read_b64_tr_b16 a[84:85], v29 offset:20480
    ds_read_b64_tr_b16 a[86:87], v29 offset:21504
    v_mul_f32 v89, v36, v89
    v_mul_f32 v90, v36, v90
    v_mul_f32 v91, v36, v91
    v_mul_f32 v92, v36, v92
    v_mul_f32 v93, v36, v93
    v_mul_f32 v94, v36, v94
    s_waitcnt lgkmcnt(15)
    v_mfma_f32_32x32x16_bf16 a[32:47], a[88:91], a[100:103], a[32:47]
    ds_read_b64_tr_b16 a[88:89], v30 offset:20480
    ds_read_b64_tr_b16 a[90:91], v30 offset:21504
    s_add_u32 m0, s74, 58368
    s_mov_b32 s47, 16448
    buffer_load_dwordx4 v32, s[36:39], s47 offen lds
    v_mul_f32 v95, v36, v95
    v_cvt_pk_bf16_f32 v184, v128, v129
    v_cvt_pk_bf16_f32 v185, v130, v131
    v_fma_f32 v136, v136, s46, -v44
    v_fma_f32 v137, v137, s46, -v44
    v_fma_f32 v138, v138, s46, -v44
    s_waitcnt lgkmcnt(15)
    v_mfma_f32_32x32x16_bf16 a[48:63], a[92:95], a[100:103], a[48:63]
    ds_read_b64_tr_b16 a[92:93], v31 offset:20480
    ds_read_b64_tr_b16 a[94:95], v31 offset:21504
    v_fma_f32 v139, v139, s46, -v44
    v_exp_f32 v136, v136
    v_exp_f32 v137, v137
    v_exp_f32 v138, v138
    v_exp_f32 v139, v139
    v_mul_f32 v96, v36, v96
    s_waitcnt vmcnt(20)
    s_barrier
    s_waitcnt lgkmcnt(15)
    v_mfma_f32_32x32x16_bf16 a[0:15], a[64:67], a[104:107], a[0:15]
    ds_read_b64_tr_b16 a[64:65], v28 offset:32768
    ds_read_b64_tr_b16 a[66:67], v28 offset:33792
    s_add_u32 m0, s74, 65536
    s_mov_b32 s47, 524288
    buffer_load_dwordx4 v7, s[28:31], s47 offen lds
    v_mul_f32 v97, v36, v97
    v_mul_f32 v98, v36, v98
    v_mul_f32 v99, v36, v99
    v_mul_f32 v100, v36, v100
    v_mul_f32 v101, v36, v101
    v_mul_f32 v102, v36, v102
    s_waitcnt lgkmcnt(15)
    v_mfma_f32_32x32x16_bf16 a[16:31], a[68:71], a[104:107], a[16:31]
    ds_read_b64_tr_b16 a[68:69], v29 offset:32768
    ds_read_b64_tr_b16 a[70:71], v29 offset:33792
    v_mul_f32 v103, v36, v103
    v_cvt_pk_bf16_f32 v186, v132, v133
    v_cvt_pk_bf16_f32 v187, v134, v135
    v_fma_f32 v140, v140, s46, -v44
    v_fma_f32 v141, v141, s46, -v44
    v_fma_f32 v142, v142, s46, -v44
    s_waitcnt lgkmcnt(15)
    v_mfma_f32_32x32x16_bf16 a[32:47], a[72:75], a[104:107], a[32:47]
    ds_read_b64_tr_b16 a[72:73], v30 offset:32768
    ds_read_b64_tr_b16 a[74:75], v30 offset:33792
    s_add_u32 m0, s74, 66560
    s_mov_b32 s47, 557056
    buffer_load_dwordx4 v7, s[28:31], s47 offen lds
    v_fma_f32 v143, v143, s46, -v44
    v_exp_f32 v140, v140
    v_exp_f32 v141, v141
    v_exp_f32 v142, v142
    v_exp_f32 v143, v143
    v_mul_f32 v104, v36, v104
    s_waitcnt lgkmcnt(15)
    v_mfma_f32_32x32x16_bf16 a[48:63], a[76:79], a[104:107], a[48:63]
    ds_read_b64_tr_b16 a[76:77], v31 offset:32768
    ds_read_b64_tr_b16 a[78:79], v31 offset:33792
    v_mul_f32 v105, v36, v105
    v_mul_f32 v106, v36, v106
    v_mul_f32 v107, v36, v107
    v_mul_f32 v108, v36, v108
    v_mul_f32 v109, v36, v109
    v_mul_f32 v110, v36, v110
    s_waitcnt lgkmcnt(14)
    v_mfma_f32_32x32x16_bf16 a[0:15], a[80:83], a[108:111], a[0:15]
    ds_read_b64_tr_b16 a[80:81], v28 offset:36864
    ds_read_b64_tr_b16 a[82:83], v28 offset:37888
    s_add_u32 m0, s74, 73728
    s_mov_b32 s47, 128
    buffer_load_dwordx4 v32, s[36:39], s47 offen lds
    v_mul_f32 v111, v36, v111
    v_cvt_pk_bf16_f32 v188, v136, v137
    v_cvt_pk_bf16_f32 v189, v138, v139
    s_nop 0
    v_cvt_pk_bf16_f32 v190, v140, v141
    v_cvt_pk_bf16_f32 v191, v142, v143
    s_waitcnt lgkmcnt(14)
    v_mfma_f32_32x32x16_bf16 a[16:31], a[84:87], a[108:111], a[16:31]
    ds_read_b64_tr_b16 a[84:85], v29 offset:36864
    ds_read_b64_tr_b16 a[86:87], v29 offset:37888
    s_waitcnt lgkmcnt(14)
    v_mfma_f32_32x32x16_bf16 a[32:47], a[88:91], a[108:111], a[32:47]
    ds_read_b64_tr_b16 a[88:89], v30 offset:36864
    ds_read_b64_tr_b16 a[90:91], v30 offset:37888
    s_add_u32 m0, s74, 74752
    s_mov_b32 s47, 16512
    buffer_load_dwordx4 v32, s[36:39], s47 offen lds
    s_waitcnt lgkmcnt(14)
    v_mfma_f32_32x32x16_bf16 a[48:63], a[92:95], a[108:111], a[48:63]
    ds_read_b64_tr_b16 a[92:93], v31 offset:36864
    ds_read_b64_tr_b16 a[94:95], v31 offset:37888
    s_nop 1
    s_waitcnt vmcnt(20)
    s_barrier
    s_waitcnt lgkmcnt(14)
    v_mfma_f32_32x32x16_bf16 v[48:63], a[64:67], v[176:179], v[48:63]
    ds_read_b64_tr_b16 a[64:65], v28 offset:40960
    ds_read_b64_tr_b16 a[66:67], v28 offset:41984
    v_fma_f32 v144, v144, s46, -v44
    v_fma_f32 v145, v145, s46, -v44
    v_fma_f32 v146, v146, s46, -v44
    v_fma_f32 v147, v147, s46, -v44
    v_exp_f32 v144, v144
    v_exp_f32 v145, v145
    s_waitcnt lgkmcnt(14)
    v_mfma_f32_32x32x16_bf16 v[64:79], a[68:71], v[176:179], v[64:79]
    ds_read_b64_tr_b16 a[68:69], v29 offset:40960
    ds_read_b64_tr_b16 a[70:71], v29 offset:41984
    s_add_u32 m0, s74, 81920
    s_mov_b32 s47, 786432
    buffer_load_dwordx4 v7, s[28:31], s47 offen lds
    v_exp_f32 v146, v146
    v_exp_f32 v147, v147
    v_fma_f32 v148, v148, s46, -v44
    v_fma_f32 v149, v149, s46, -v44
    v_fma_f32 v150, v150, s46, -v44
    v_fma_f32 v151, v151, s46, -v44
    s_waitcnt lgkmcnt(14)
    v_mfma_f32_32x32x16_bf16 v[80:95], a[72:75], v[176:179], v[80:95]
    ds_read_b64_tr_b16 a[72:73], v30 offset:40960
    ds_read_b64_tr_b16 a[74:75], v30 offset:41984
    v_exp_f32 v148, v148
    v_exp_f32 v149, v149
    v_exp_f32 v150, v150
    v_exp_f32 v151, v151
    v_cvt_pk_bf16_f32 v192, v144, v145
    v_cvt_pk_bf16_f32 v193, v146, v147
    s_waitcnt lgkmcnt(14)
    v_mfma_f32_32x32x16_bf16 v[96:111], a[76:79], v[176:179], v[96:111]
    ds_read_b64_tr_b16 a[76:77], v31 offset:40960
    ds_read_b64_tr_b16 a[78:79], v31 offset:41984
    v_fma_f32 v152, v152, s46, -v44
    v_fma_f32 v153, v153, s46, -v44
    v_fma_f32 v154, v154, s46, -v44
    v_fma_f32 v155, v155, s46, -v44
    v_exp_f32 v152, v152
    v_exp_f32 v153, v153
    s_waitcnt lgkmcnt(14)
    v_mfma_f32_32x32x16_bf16 v[48:63], a[80:83], v[180:183], v[48:63]
    ds_read_b64_tr_b16 a[80:81], v28 offset:45056
    ds_read_b64_tr_b16 a[82:83], v28 offset:46080
    v_exp_f32 v154, v154
    v_exp_f32 v155, v155
    v_cvt_pk_bf16_f32 v194, v148, v149
    v_cvt_pk_bf16_f32 v195, v150, v151
    v_fma_f32 v156, v156, s46, -v44
    v_fma_f32 v157, v157, s46, -v44
    s_waitcnt lgkmcnt(14)
    v_mfma_f32_32x32x16_bf16 v[64:79], a[84:87], v[180:183], v[64:79]
    ds_read_b64_tr_b16 a[84:85], v29 offset:45056
    ds_read_b64_tr_b16 a[86:87], v29 offset:46080
    s_add_u32 m0, s74, 82944
    s_mov_b32 s47, 819200
    buffer_load_dwordx4 v7, s[28:31], s47 offen lds
    v_fma_f32 v158, v158, s46, -v44
    v_fma_f32 v159, v159, s46, -v44
    v_exp_f32 v156, v156
    v_exp_f32 v157, v157
    v_exp_f32 v158, v158
    v_exp_f32 v159, v159
    s_waitcnt lgkmcnt(14)
    v_mfma_f32_32x32x16_bf16 v[80:95], a[88:91], v[180:183], v[80:95]
    ds_read_b64_tr_b16 a[88:89], v30 offset:45056
    ds_read_b64_tr_b16 a[90:91], v30 offset:46080
    v_cvt_pk_bf16_f32 v196, v152, v153
    v_cvt_pk_bf16_f32 v197, v154, v155
    v_fma_f32 v160, v160, s46, -v44
    v_fma_f32 v161, v161, s46, -v44
    v_fma_f32 v162, v162, s46, -v44
    v_fma_f32 v163, v163, s46, -v44
    s_waitcnt lgkmcnt(14)
    v_mfma_f32_32x32x16_bf16 v[96:111], a[92:95], v[180:183], v[96:111]
    ds_read_b64_tr_b16 a[92:93], v31 offset:45056
    ds_read_b64_tr_b16 a[94:95], v31 offset:46080
    v_exp_f32 v160, v160
    v_exp_f32 v161, v161
    v_exp_f32 v162, v162
    v_exp_f32 v163, v163
    v_cvt_pk_bf16_f32 v198, v156, v157
    v_cvt_pk_bf16_f32 v199, v158, v159
    s_waitcnt lgkmcnt(14)
    v_mfma_f32_32x32x16_bf16 v[48:63], a[64:67], v[184:187], v[48:63]
    ds_read_b64_tr_b16 a[64:65], v28 offset:49152
    ds_read_b64_tr_b16 a[66:67], v28 offset:50176
    v_fma_f32 v164, v164, s46, -v44
    v_fma_f32 v165, v165, s46, -v44
    v_fma_f32 v166, v166, s46, -v44
    v_fma_f32 v167, v167, s46, -v44
    v_exp_f32 v164, v164
    v_exp_f32 v165, v165
    s_waitcnt lgkmcnt(14)
    v_mfma_f32_32x32x16_bf16 v[64:79], a[68:71], v[184:187], v[64:79]
    ds_read_b64_tr_b16 a[68:69], v29 offset:49152
    ds_read_b64_tr_b16 a[70:71], v29 offset:50176
    s_add_u32 m0, s74, 90112
    s_mov_b32 s47, 192
    buffer_load_dwordx4 v32, s[36:39], s47 offen lds
    v_exp_f32 v166, v166
    v_exp_f32 v167, v167
    v_cvt_pk_bf16_f32 v200, v160, v161
    v_cvt_pk_bf16_f32 v201, v162, v163
    v_fma_f32 v168, v168, s46, -v44
    v_fma_f32 v169, v169, s46, -v44
    s_waitcnt lgkmcnt(14)
    v_mfma_f32_32x32x16_bf16 v[80:95], a[72:75], v[184:187], v[80:95]
    ds_read_b64_tr_b16 a[72:73], v30 offset:49152
    ds_read_b64_tr_b16 a[74:75], v30 offset:50176
    v_fma_f32 v170, v170, s46, -v44
    v_fma_f32 v171, v171, s46, -v44
    v_exp_f32 v168, v168
    v_exp_f32 v169, v169
    v_exp_f32 v170, v170
    v_exp_f32 v171, v171
    s_waitcnt lgkmcnt(14)
    v_mfma_f32_32x32x16_bf16 v[96:111], a[76:79], v[184:187], v[96:111]
    ds_read_b64_tr_b16 a[76:77], v31 offset:49152
    ds_read_b64_tr_b16 a[78:79], v31 offset:50176
    v_cvt_pk_bf16_f32 v202, v164, v165
    v_cvt_pk_bf16_f32 v203, v166, v167
    v_fma_f32 v172, v172, s46, -v44
    v_fma_f32 v173, v173, s46, -v44
    v_fma_f32 v174, v174, s46, -v44
    v_fma_f32 v175, v175, s46, -v44
    s_waitcnt lgkmcnt(14)
    v_mfma_f32_32x32x16_bf16 v[48:63], a[80:83], v[188:191], v[48:63]
    ds_read_b64_tr_b16 a[80:81], v28 offset:53248
    ds_read_b64_tr_b16 a[82:83], v28 offset:54272
    v_exp_f32 v172, v172
    v_exp_f32 v173, v173
    v_exp_f32 v174, v174
    v_exp_f32 v175, v175
    v_cvt_pk_bf16_f32 v204, v168, v169
    v_cvt_pk_bf16_f32 v205, v170, v171
    s_waitcnt lgkmcnt(14)
    v_mfma_f32_32x32x16_bf16 v[64:79], a[84:87], v[188:191], v[64:79]
    ds_read_b64_tr_b16 a[84:85], v29 offset:53248
    ds_read_b64_tr_b16 a[86:87], v29 offset:54272
    s_add_u32 m0, s74, 91136
    s_mov_b32 s47, 16576
    buffer_load_dwordx4 v32, s[36:39], s47 offen lds
    s_nop 0
    v_cvt_pk_bf16_f32 v206, v172, v173
    v_cvt_pk_bf16_f32 v207, v174, v175
    s_waitcnt lgkmcnt(14)
    v_mfma_f32_32x32x16_bf16 v[80:95], a[88:91], v[188:191], v[80:95]
    ds_read_b64_tr_b16 a[88:89], v30 offset:53248
    ds_read_b64_tr_b16 a[90:91], v30 offset:54272
    s_waitcnt lgkmcnt(14)
    v_mfma_f32_32x32x16_bf16 v[96:111], a[92:95], v[188:191], v[96:111]
    ds_read_b64_tr_b16 a[92:93], v31 offset:53248
    ds_read_b64_tr_b16 a[94:95], v31 offset:54272
    s_nop 1
    s_waitcnt vmcnt(20)
    s_barrier
    s_waitcnt lgkmcnt(14)
    v_mfma_f32_32x32x16_bf16 v[48:63], a[64:67], v[192:195], v[48:63]
    ds_read_b64_tr_b16 a[64:65], v28 offset:57344
    ds_read_b64_tr_b16 a[66:67], v28 offset:58368
    v_add_f32 v40, v112, v113
    v_accvgpr_read_b32 v240, a0
    v_accvgpr_read_b32 v241, a1
    v_add_f32 v41, v128, v129
    v_accvgpr_read_b32 v242, a2
    v_add_f32 v42, v144, v145
    v_accvgpr_read_b32 v243, a3
    v_accvgpr_read_b32 v244, a4
    v_add_f32 v43, v160, v161
    v_accvgpr_read_b32 v245, a5
    v_add_f32 v40, v40, v114
    s_waitcnt lgkmcnt(14)
    v_mfma_f32_32x32x16_bf16 v[64:79], a[68:71], v[192:195], v[64:79]
    ds_read_b64_tr_b16 a[68:69], v29 offset:57344
    ds_read_b64_tr_b16 a[70:71], v29 offset:58368
    s_add_u32 m0, s45, 98304
    s_mov_b32 s47, 0
    buffer_load_dwordx4 v6, s[20:23], s47 offen offset:0 nt lds
    v_accvgpr_read_b32 v246, a6
    v_accvgpr_read_b32 v247, a7
    v_add_f32 v41, v41, v130
    v_cvt_pk_bf16_f32 v208, v240, v241
    v_add_f32 v42, v42, v146
    v_cvt_pk_bf16_f32 v209, v242, v243
    v_cvt_pk_bf16_f32 v210, v244, v245
    v_add_f32 v43, v43, v162
    v_cvt_pk_bf16_f32 v211, v246, v247
    v_add_f32 v40, v40, v115
    v_accvgpr_read_b32 v240, a8
    s_waitcnt lgkmcnt(14)
    v_mfma_f32_32x32x16_bf16 v[80:95], a[72:75], v[192:195], v[80:95]
    ds_read_b64_tr_b16 a[72:73], v30 offset:57344
    ds_read_b64_tr_b16 a[74:75], v30 offset:58368
    v_accvgpr_read_b32 v241, a9
    v_add_f32 v41, v41, v131
    v_accvgpr_read_b32 v242, a10
    v_add_f32 v42, v42, v147
    v_accvgpr_read_b32 v243, a11
    v_accvgpr_read_b32 v244, a12
    v_add_f32 v43, v43, v163
    v_accvgpr_read_b32 v245, a13
    v_add_f32 v40, v40, v116
    v_accvgpr_read_b32 v246, a14
    v_accvgpr_read_b32 v247, a15
    s_waitcnt lgkmcnt(14)
    v_mfma_f32_32x32x16_bf16 v[96:111], a[76:79], v[192:195], v[96:111]
    ds_read_b64_tr_b16 a[76:77], v31 offset:57344
    ds_read_b64_tr_b16 a[78:79], v31 offset:58368
    v_add_f32 v41, v41, v132
    v_cvt_pk_bf16_f32 v212, v240, v241
    v_add_f32 v42, v42, v148
    v_cvt_pk_bf16_f32 v213, v242, v243
    v_cvt_pk_bf16_f32 v214, v244, v245
    v_add_f32 v43, v43, v164
    v_cvt_pk_bf16_f32 v215, v246, v247
    v_add_f32 v40, v40, v117
    v_accvgpr_read_b32 v240, a16
    v_accvgpr_read_b32 v241, a17
    v_add_f32 v41, v41, v133
    s_waitcnt lgkmcnt(14)
    v_mfma_f32_32x32x16_bf16 v[48:63], a[80:83], v[196:199], v[48:63]
    ds_read_b64_tr_b16 a[80:81], v28 offset:61440
    ds_read_b64_tr_b16 a[82:83], v28 offset:62464
    v_accvgpr_read_b32 v242, a18
    v_add_f32 v42, v42, v149
    v_accvgpr_read_b32 v243, a19
    v_accvgpr_read_b32 v244, a20
    v_add_f32 v43, v43, v165
    v_accvgpr_read_b32 v245, a21
    v_add_f32 v40, v40, v118
    v_accvgpr_read_b32 v246, a22
    v_accvgpr_read_b32 v247, a23
    v_add_f32 v41, v41, v134
    v_cvt_pk_bf16_f32 v216, v240, v241
    s_waitcnt lgkmcnt(14)
    v_mfma_f32_32x32x16_bf16 v[64:79], a[84:87], v[196:199], v[64:79]
    ds_read_b64_tr_b16 a[84:85], v29 offset:61440
    ds_read_b64_tr_b16 a[86:87], v29 offset:62464
    s_add_u32 m0, s45, 98304
    s_mov_b32 s47, 0
    buffer_load_dwordx4 v6, s[20:23], s47 offen offset:1024 nt lds
    v_add_f32 v42, v42, v150
    v_cvt_pk_bf16_f32 v217, v242, v243
    v_cvt_pk_bf16_f32 v218, v244, v245
    v_add_f32 v43, v43, v166
    v_cvt_pk_bf16_f32 v219, v246, v247
    v_add_f32 v40, v40, v119
    v_accvgpr_read_b32 v240, a24
    v_accvgpr_read_b32 v241, a25
    v_add_f32 v41, v41, v135
    v_accvgpr_read_b32 v242, a26
    v_add_f32 v42, v42, v151
    s_waitcnt lgkmcnt(14)
    v_mfma_f32_32x32x16_bf16 v[80:95], a[88:91], v[196:199], v[80:95]
    ds_read_b64_tr_b16 a[88:89], v30 offset:61440
    ds_read_b64_tr_b16 a[90:91], v30 offset:62464
    v_accvgpr_read_b32 v243, a27
    v_accvgpr_read_b32 v244, a28
    v_add_f32 v43, v43, v167
    v_accvgpr_read_b32 v245, a29
    v_add_f32 v40, v40, v120
    v_accvgpr_read_b32 v246, a30
    v_accvgpr_read_b32 v247, a31
    v_add_f32 v41, v41, v136
    v_cvt_pk_bf16_f32 v220, v240, v241
    v_add_f32 v42, v42, v152
    v_cvt_pk_bf16_f32 v221, v242, v243
    s_waitcnt lgkmcnt(14)
    v_mfma_f32_32x32x16_bf16 v[96:111], a[92:95], v[196:199], v[96:111]
    ds_read_b64_tr_b16 a[92:93], v31 offset:61440
    ds_read_b64_tr_b16 a[94:95], v31 offset:62464
    v_cvt_pk_bf16_f32 v222, v244, v245
    v_add_f32 v43, v43, v168
    v_cvt_pk_bf16_f32 v223, v246, v247
    v_add_f32 v40, v40, v121
    v_accvgpr_read_b32 v240, a32
    v_accvgpr_read_b32 v241, a33
    v_add_f32 v41, v41, v137
    v_accvgpr_read_b32 v242, a34
    v_add_f32 v42, v42, v153
    v_accvgpr_read_b32 v243, a35
    v_accvgpr_read_b32 v244, a36
    s_waitcnt lgkmcnt(14)
    v_mfma_f32_32x32x16_bf16 v[48:63], a[64:67], v[200:203], v[48:63]
    ds_read_b128 a[64:67], v8 offset:0
    v_add_f32 v43, v43, v169
    v_accvgpr_read_b32 v245, a37
    v_add_f32 v40, v40, v122
    v_accvgpr_read_b32 v246, a38
    v_accvgpr_read_b32 v247, a39
    v_add_f32 v41, v41, v138
    v_cvt_pk_bf16_f32 v224, v240, v241
    v_add_f32 v42, v42, v154
    v_cvt_pk_bf16_f32 v225, v242, v243
    v_cvt_pk_bf16_f32 v226, v244, v245
    v_add_f32 v43, v43, v170
    s_waitcnt lgkmcnt(13)
    v_mfma_f32_32x32x16_bf16 v[64:79], a[68:71], v[200:203], v[64:79]
    ds_read_b128 a[68:71], v9 offset:0
    s_add_u32 m0, s45, 98304
    s_mov_b32 s47, 0
    buffer_load_dwordx4 v6, s[20:23], s47 offen offset:2048 nt lds
    v_cvt_pk_bf16_f32 v227, v246, v247
    v_add_f32 v40, v40, v123
    v_accvgpr_read_b32 v240, a40
    v_accvgpr_read_b32 v241, a41
    v_add_f32 v41, v41, v139
    v_accvgpr_read_b32 v242, a42
    v_add_f32 v42, v42, v155
    v_accvgpr_read_b32 v243, a43
    v_accvgpr_read_b32 v244, a44
    v_add_f32 v43, v43, v171
    v_accvgpr_read_b32 v245, a45
    s_waitcnt lgkmcnt(12)
    v_mfma_f32_32x32x16_bf16 v[80:95], a[72:75], v[200:203], v[80:95]
    ds_read_b128 a[72:75], v10 offset:0
    v_add_f32 v40, v40, v124
    v_accvgpr_read_b32 v246, a46
    v_accvgpr_read_b32 v247, a47
    v_add_f32 v41, v41, v140
    v_cvt_pk_bf16_f32 v228, v240, v241
    v_add_f32 v42, v42, v156
    v_cvt_pk_bf16_f32 v229, v242, v243
    v_cvt_pk_bf16_f32 v230, v244, v245
    v_add_f32 v43, v43, v172
    v_cvt_pk_bf16_f32 v231, v246, v247
    v_add_f32 v40, v40, v125
    s_waitcnt lgkmcnt(11)
    v_mfma_f32_32x32x16_bf16 v[96:111], a[76:79], v[200:203], v[96:111]
    ds_read_b128 a[76:79], v11 offset:0
    v_accvgpr_read_b32 v240, a48
    v_accvgpr_read_b32 v241, a49
    v_add_f32 v41, v41, v141
    v_accvgpr_read_b32 v242, a50
    v_add_f32 v42, v42, v157
    v_accvgpr_read_b32 v243, a51
    v_accvgpr_read_b32 v244, a52
    v_add_f32 v43, v43, v173
    v_accvgpr_read_b32 v245, a53
    v_add_f32 v40, v40, v126
    v_accvgpr_read_b32 v246, a54
    s_waitcnt lgkmcnt(10)
    v_mfma_f32_32x32x16_bf16 v[48:63], a[80:83], v[204:207], v[48:63]
    ds_read_b128 a[80:83], v12 offset:0
    v_accvgpr_read_b32 v247, a55
    v_add_f32 v41, v41, v142
    v_cvt_pk_bf16_f32 v232, v240, v241
    v_add_f32 v42, v42, v158
    v_cvt_pk_bf16_f32 v233, v242, v243
    v_cvt_pk_bf16_f32 v234, v244, v245
    v_add_f32 v43, v43, v174
    v_cvt_pk_bf16_f32 v235, v246, v247
    v_add_f32 v40, v40, v127
    v_accvgpr_read_b32 v240, a56
    v_accvgpr_read_b32 v241, a57
    s_waitcnt lgkmcnt(9)
    v_mfma_f32_32x32x16_bf16 v[64:79], a[84:87], v[204:207], v[64:79]
    ds_read_b128 a[84:87], v13 offset:0
    s_add_u32 m0, s45, 98304
    s_mov_b32 s47, 0
    buffer_load_dwordx4 v6, s[20:23], s47 offen offset:3072 nt lds
    v_add_f32 v41, v41, v143
    v_accvgpr_read_b32 v242, a58
    v_add_f32 v42, v42, v159
    v_accvgpr_read_b32 v243, a59
    v_accvgpr_read_b32 v244, a60
    v_add_f32 v43, v43, v175
    v_accvgpr_read_b32 v245, a61
    v_add_f32 v40, v40, v41
    v_accvgpr_read_b32 v246, a62
    v_accvgpr_read_b32 v247, a63
    v_add_f32 v42, v42, v43
    s_waitcnt lgkmcnt(8)
    v_mfma_f32_32x32x16_bf16 v[80:95], a[88:91], v[204:207], v[80:95]
    ds_read_b128 a[88:91], v14 offset:0
    v_cvt_pk_bf16_f32 v236, v240, v241
    v_add_f32 v40, v40, v42
    v_cvt_pk_bf16_f32 v237, v242, v243
    v_cvt_pk_bf16_f32 v238, v244, v245
    v_fma_f32 v35, v35, v36, v40
    v_cvt_pk_bf16_f32 v239, v246, v247
    s_waitcnt lgkmcnt(7)
    v_mfma_f32_32x32x16_bf16 v[96:111], a[92:95], v[204:207], v[96:111]
    ds_read_b128 a[92:95], v15 offset:0
    s_nop 1
    s_and_b32 s52, s48, 1
    s_lshl_b32 s52, s52, 3
    s_add_u32 s52, s52, s50
    s_lshr_b32 s51, s48, 1
    s_lshl_b32 s53, s51, 6
    s_lshl_b32 s54, s52, 2
    s_add_u32 s53, s53, s54
    s_add_u32 s53, s53, s44
    s_lshl_b32 s53, s53, 8
    s_lshl_b32 s54, s49, 3
    s_add_u32 s53, s53, s54
    s_lshl_b32 s53, s53, 10
    s_add_u32 s40, s72, s53
    s_addc_u32 s41, s73, 0
    s_mov_b32 s42, 8192
    s_mov_b32 s43, 0x20000
    s_mov_b64 s[8:9], s[16:17]
    s_mov_b64 s[10:11], s[18:19]
    s_mov_b64 s[12:13], s[20:21]
    s_mov_b64 s[14:15], s[22:23]
    s_mov_b64 s[24:25], s[28:29]
    s_mov_b64 s[26:27], s[30:31]
    s_mov_b64 s[32:33], s[36:37]
    s_mov_b64 s[34:35], s[38:39]
    s_add_u32 s55, s48, 2
    s_and_b32 s52, s55, 1
    s_lshl_b32 s52, s52, 3
    s_add_u32 s52, s52, s50
    s_lshr_b32 s51, s55, 1
    s_lshl_b32 s53, s52, 5
    s_add_u32 s53, s53, s49
    s_lshl_b32 s53, s53, 17
    s_cmp_eq_u32 s51, 0
    s_cselect_b32 s16, s58, s66
    s_cselect_b32 s17, s59, s67
    s_add_u32 s16, s16, s53
    s_addc_u32 s17, s17, 0
    s_cmp_lt_u32 s51, 2
    s_cselect_b32 s18, 131072, 0
    s_mov_b32 s19, 0x20000
    s_cmp_eq_u32 s51, 0
    s_cselect_b32 s20, s60, s68
    s_cselect_b32 s21, s61, s69
    s_add_u32 s20, s20, s53
    s_addc_u32 s21, s21, 0
    s_cmp_lt_u32 s51, 2
    s_cselect_b32 s22, 131072, 0
    s_mov_b32 s23, 0x20000
    s_add_u32 s55, s48, 3
    s_and_b32 s52, s55, 1
    s_lshl_b32 s52, s52, 3
    s_add_u32 s52, s52, s50
    s_lshr_b32 s51, s55, 1
    s_cmp_eq_u32 s51, 0
    s_cselect_b32 s28, s62, s70
    s_cselect_b32 s29, s63, s71
    s_lshl_b32 s53, s49, 8
    s_add_u32 s28, s28, s53
    s_addc_u32 s29, s29, 0
    s_sub_u32 s53, 4194304, s53
    s_cmp_lt_u32 s51, 2
    s_cselect_b32 s30, s53, 0
    s_mov_b32 s31, 0x20000
    s_cmp_eq_u32 s51, 0
    s_cselect_b32 s36, s56, s64
    s_cselect_b32 s37, s57, s65
    s_lshl_b32 s53, s52, 17
    s_add_u32 s36, s36, s53
    s_addc_u32 s37, s37, 0
    s_cmp_lt_u32 s51, 2
    s_cselect_b32 s38, 131072, 0
    s_mov_b32 s39, 0x20000
    s_add_u32 s48, s48, 1
    s_cmp_lt_u32 s48, 4
    s_cbranch_scc1 attn_loop
    s_nop 15
    v_mov_b32 v248, v35
    s_nop 1
    v_permlane32_swap_b32 v35, v248
    s_nop 1
    v_add_f32 v35, v35, v248
    v_rcp_f32 v35, v35
    s_nop 0
    v_mul_f32 v48, v35, v48
    v_mul_f32 v49, v35, v49
    v_mul_f32 v50, v35, v50
    v_mul_f32 v51, v35, v51
    v_mul_f32 v52, v35, v52
    v_mul_f32 v53, v35, v53
    v_mul_f32 v54, v35, v54
    v_mul_f32 v55, v35, v55
    v_cvt_pk_bf16_f32 v176, v48, v49
    v_cvt_pk_bf16_f32 v177, v50, v51
    v_cvt_pk_bf16_f32 v178, v52, v53
    v_cvt_pk_bf16_f32 v179, v54, v55
    buffer_store_dwordx4 v[176:179], v33, s[40:43], 0 offen offset:0 sc1
    v_mul_f32 v56, v35, v56
    v_mul_f32 v57, v35, v57
    v_mul_f32 v58, v35, v58
    v_mul_f32 v59, v35, v59
    v_mul_f32 v60, v35, v60
    v_mul_f32 v61, v35, v61
    v_mul_f32 v62, v35, v62
    v_mul_f32 v63, v35, v63
    v_cvt_pk_bf16_f32 v180, v56, v57
    v_cvt_pk_bf16_f32 v181, v58, v59
    v_cvt_pk_bf16_f32 v182, v60, v61
    v_cvt_pk_bf16_f32 v183, v62, v63
    buffer_store_dwordx4 v[180:183], v33, s[40:43], 0 offen offset:1024 sc1
    v_mul_f32 v64, v35, v64
    v_mul_f32 v65, v35, v65
    v_mul_f32 v66, v35, v66
    v_mul_f32 v67, v35, v67
    v_mul_f32 v68, v35, v68
    v_mul_f32 v69, v35, v69
    v_mul_f32 v70, v35, v70
    v_mul_f32 v71, v35, v71
    v_cvt_pk_bf16_f32 v184, v64, v65
    v_cvt_pk_bf16_f32 v185, v66, v67
    v_cvt_pk_bf16_f32 v186, v68, v69
    v_cvt_pk_bf16_f32 v187, v70, v71
    buffer_store_dwordx4 v[184:187], v33, s[40:43], 0 offen offset:2048 sc1
    v_mul_f32 v72, v35, v72
    v_mul_f32 v73, v35, v73
    v_mul_f32 v74, v35, v74
    v_mul_f32 v75, v35, v75
    v_mul_f32 v76, v35, v76
    v_mul_f32 v77, v35, v77
    v_mul_f32 v78, v35, v78
    v_mul_f32 v79, v35, v79
    v_cvt_pk_bf16_f32 v188, v72, v73
    v_cvt_pk_bf16_f32 v189, v74, v75
    v_cvt_pk_bf16_f32 v190, v76, v77
    v_cvt_pk_bf16_f32 v191, v78, v79
    buffer_store_dwordx4 v[188:191], v33, s[40:43], 0 offen offset:3072 sc1
    v_mul_f32 v80, v35, v80
    v_mul_f32 v81, v35, v81
    v_mul_f32 v82, v35, v82
    v_mul_f32 v83, v35, v83
    v_mul_f32 v84, v35, v84
    v_mul_f32 v85, v35, v85
    v_mul_f32 v86, v35, v86
    v_mul_f32 v87, v35, v87
    v_cvt_pk_bf16_f32 v192, v80, v81
    v_cvt_pk_bf16_f32 v193, v82, v83
    v_cvt_pk_bf16_f32 v194, v84, v85
    v_cvt_pk_bf16_f32 v195, v86, v87
    s_mov_b32 s51, 4096
    buffer_store_dwordx4 v[192:195], v33, s[40:43], s51 offen offset:0 sc1
    v_mul_f32 v88, v35, v88
    v_mul_f32 v89, v35, v89
    v_mul_f32 v90, v35, v90
    v_mul_f32 v91, v35, v91
    v_mul_f32 v92, v35, v92
    v_mul_f32 v93, v35, v93
    v_mul_f32 v94, v35, v94
    v_mul_f32 v95, v35, v95
    v_cvt_pk_bf16_f32 v196, v88, v89
    v_cvt_pk_bf16_f32 v197, v90, v91
    v_cvt_pk_bf16_f32 v198, v92, v93
    v_cvt_pk_bf16_f32 v199, v94, v95
    buffer_store_dwordx4 v[196:199], v33, s[40:43], s51 offen offset:1024 sc1
    v_mul_f32 v96, v35, v96
    v_mul_f32 v97, v35, v97
    v_mul_f32 v98, v35, v98
    v_mul_f32 v99, v35, v99
    v_mul_f32 v100, v35, v100
    v_mul_f32 v101, v35, v101
    v_mul_f32 v102, v35, v102
    v_mul_f32 v103, v35, v103
    v_cvt_pk_bf16_f32 v200, v96, v97
    v_cvt_pk_bf16_f32 v201, v98, v99
    v_cvt_pk_bf16_f32 v202, v100, v101
    v_cvt_pk_bf16_f32 v203, v102, v103
    buffer_store_dwordx4 v[200:203], v33, s[40:43], s51 offen offset:2048 sc1
    v_mul_f32 v104, v35, v104
    v_mul_f32 v105, v35, v105
    v_mul_f32 v106, v35, v106
    v_mul_f32 v107, v35, v107
    v_mul_f32 v108, v35, v108
    v_mul_f32 v109, v35, v109
    v_mul_f32 v110, v35, v110
    v_mul_f32 v111, v35, v111
    v_cvt_pk_bf16_f32 v204, v104, v105
    v_cvt_pk_bf16_f32 v205, v106, v107
    v_cvt_pk_bf16_f32 v206, v108, v109
    v_cvt_pk_bf16_f32 v207, v110, v111
    buffer_store_dwordx4 v[204:207], v33, s[40:43], s51 offen offset:3072 sc1
attn_done:
    s_endpgm
.globl oproj_kernel
.p2align 8
.type oproj_kernel,@function
oproj_kernel:
    s_cmp_ge_u32 s2, 256
    s_cbranch_scc1 oproj_done
    s_and_b32 s3, s2, 7
    s_lshr_b32 s4, s2, 3
    s_lshr_b32 s47, s3, 2
    s_and_b32 s5, s3, 3
    s_lshl_b32 s5, s5, 2
    s_lshr_b32 s6, s4, 3
    s_add_u32 s48, s5, s6
    s_bfe_u32 s49, s4, 0x20001
    s_and_b32 s50, s4, 1
    s_mul_i32 s3, s47, 40
    s_add_u32 s4, s0, s3
    s_addc_u32 s5, s1, 0
    s_load_dwordx2 s[56:57], s[4:5], 32
    s_load_dwordx2 s[58:59], s[0:1], 80
    s_load_dwordx2 s[60:61], s[0:1], 96
    v_lshrrev_b32 v1, 6, v0
    v_and_b32 v0, 63, v0
    v_readfirstlane_b32 s44, v1
    s_nop 3
    s_lshl_b32 s45, s44, 12
    v_lshrrev_b32 v16, 4, v0
    v_and_b32 v17, 15, v0
    s_lshl_b32 s3, s44, 4
    v_add_u32 v18, s3, v16
    v_lshlrev_b32 v19, 2, v16
    v_xor_b32 v19, v19, v17
    v_lshlrev_b32 v19, 4, v19
    v_lshl_add_u32 v2, v18, 10, v19
    v_lshlrev_b32 v3, 4, v0
    v_lshrrev_b32 v17, 5, v0
    v_bfe_u32 v16, v0, 2, 2
    v_and_b32 v18, 3, v0
    v_bfe_u32 v19, v0, 4, 1
    v_and_b32 v20, 1, v18
    v_lshlrev_b32 v20, 1, v20
    v_lshrrev_b32 v21, 1, v18
    v_or_b32 v20, v20, v21
    v_lshl_add_u32 v21, v17, 3, v16
    v_lshlrev_b32 v21, 8, v21
    v_lshrrev_b32 v22, 1, v20
    v_lshl_add_u32 v22, v19, 1, v22
    v_lshl_add_u32 v21, v22, 4, v21
    v_and_b32 v22, 1, v20
    v_lshl_add_u32 v21, v22, 3, v21
    v_xor_b32 v22, 0, v16
    v_lshl_add_u32 v4, v22, 6, v21
    v_add_u32 v8, 0x10000, v4
    v_xor_b32 v22, 1, v16
    v_lshl_add_u32 v5, v22, 6, v21
    v_add_u32 v9, 0x10000, v5
    v_xor_b32 v22, 2, v16
    v_lshl_add_u32 v6, v22, 6, v21
    v_add_u32 v10, 0x10000, v6
    v_xor_b32 v22, 3, v16
    v_lshl_add_u32 v7, v22, 6, v21
    v_add_u32 v11, 0x10000, v7
    v_mov_b32 v32, 0
    v_mov_b32 v33, 0
    v_mov_b32 v34, 0
    v_mov_b32 v35, 0
    v_mov_b32 v36, 0
    v_mov_b32 v37, 0
    v_mov_b32 v38, 0
    v_mov_b32 v39, 0
    v_mov_b32 v40, 0
    v_mov_b32 v41, 0
    v_mov_b32 v42, 0
    v_mov_b32 v43, 0
    v_mov_b32 v44, 0
    v_mov_b32 v45, 0
    v_mov_b32 v46, 0
    v_mov_b32 v47, 0
    v_mov_b32 v48, 0
    v_mov_b32 v49, 0
    v_mov_b32 v50, 0
    v_mov_b32 v51, 0
    v_mov_b32 v52, 0
    v_mov_b32 v53, 0
    v_mov_b32 v54, 0
    v_mov_b32 v55, 0
    v_mov_b32 v56, 0
    v_mov_b32 v57, 0
    v_mov_b32 v58, 0
    v_mov_b32 v59, 0
    v_mov_b32 v60, 0
    v_mov_b32 v61, 0
    v_mov_b32 v62, 0
    v_mov_b32 v63, 0
    v_mov_b32 v64, 0
    v_mov_b32 v65, 0
    v_mov_b32 v66, 0
    v_mov_b32 v67, 0
    v_mov_b32 v68, 0
    v_mov_b32 v69, 0
    v_mov_b32 v70, 0
    v_mov_b32 v71, 0
    v_mov_b32 v72, 0
    v_mov_b32 v73, 0
    v_mov_b32 v74, 0
    v_mov_b32 v75, 0
    v_mov_b32 v76, 0
    v_mov_b32 v77, 0
    v_mov_b32 v78, 0
    v_mov_b32 v79, 0
    v_mov_b32 v80, 0
    v_mov_b32 v81, 0
    v_mov_b32 v82, 0
    v_mov_b32 v83, 0
    v_mov_b32 v84, 0
    v_mov_b32 v85, 0
    v_mov_b32 v86, 0
    v_mov_b32 v87, 0
    v_mov_b32 v88, 0
    v_mov_b32 v89, 0
    v_mov_b32 v90, 0
    v_mov_b32 v91, 0
    v_mov_b32 v92, 0
    v_mov_b32 v93, 0
    v_mov_b32 v94, 0
    v_mov_b32 v95, 0
    s_waitcnt lgkmcnt(0)
    s_lshl_b32 s3, s50, 21
    s_lshl_b32 s4, s49, 8
    s_add_u32 s3, s3, s4
    s_add_u32 s8, s56, s3
    s_addc_u32 s9, s57, 0
    s_sub_u32 s10, 4194304, s3
    s_mov_b32 s11, 0x20000
    s_lshl_b32 s3, s47, 6
    s_lshl_b32 s4, s48, 2
    s_add_u32 s3, s3, s4
    s_add_u32 s3, s3, s44
    s_lshl_b32 s3, s3, 18
    s_lshl_b32 s4, s50, 17
    s_add_u32 s3, s3, s4
    s_add_u32 s12, s60, s3
    s_addc_u32 s13, s61, 0
    s_mov_b32 s14, 131072
    s_mov_b32 s15, 0x20000
    s_lshl_b32 s3, s48, 7
    s_lshl_b32 s4, s44, 5
    s_add_u32 s3, s3, s4
    s_lshl_b32 s3, s3, 11
    s_lshl_b32 s4, s47, 10
    s_add_u32 s3, s3, s4
    s_lshl_b32 s4, s49, 8
    s_add_u32 s3, s3, s4
    s_lshl_b32 s4, s50, 7
    s_add_u32 s3, s3, s4
    s_add_u32 s16, s58, s3
    s_addc_u32 s17, s59, 0
    s_sub_u32 s18, 4194304, s3
    s_mov_b32 s19, 0x20000
    s_xor_b32 s3, s2, 0
    s_lshl_b32 s3, s3, 15
    s_lshl_b32 s4, s44, 13
    s_add_u32 s3, s3, s4
    s_add_u32 s3, s3, 0x4000000
    s_add_u32 s20, s60, s3
    s_addc_u32 s21, s61, 0
    s_mov_b32 s22, 8192
    s_mov_b32 s23, 0x20000
    s_xor_b32 s3, s2, 8
    s_lshl_b32 s3, s3, 15
    s_lshl_b32 s4, s44, 13
    s_add_u32 s3, s3, s4
    s_add_u32 s3, s3, 0x4000000
    s_add_u32 s24, s60, s3
    s_addc_u32 s25, s61, 0
    s_mov_b32 s26, 8192
    s_mov_b32 s27, 0x20000
    s_add_u32 s28, s60, 0x6000000
    s_addc_u32 s29, s61, 0
    s_mov_b32 s30, 32768
    s_mov_b32 s31, 0x20000
    s_mov_b32 s52, 0
    s_mov_b32 s53, 0
    s_mov_b32 s51, 0
    s_add_u32 m0, s45, 0
    s_add_u32 s46, s52, 0
    buffer_load_dwordx4 v2, s[8:11], s46 offen lds
    s_add_u32 s46, s53, 0
    buffer_load_dwordx4 a[32:35], v3, s[12:15], s46 offen offset:0
    s_add_u32 m0, s45, 1024
    s_add_u32 s46, s52, 4096
    buffer_load_dwordx4 v2, s[8:11], s46 offen lds
    s_add_u32 s46, s53, 0
    buffer_load_dwordx4 a[36:39], v3, s[12:15], s46 offen offset:1024
    s_add_u32 m0, s45, 2048
    s_add_u32 s46, s52, 8192
    buffer_load_dwordx4 v2, s[8:11], s46 offen lds
    s_add_u32 s46, s53, 0
    buffer_load_dwordx4 a[40:43], v3, s[12:15], s46 offen offset:2048
    s_add_u32 m0, s45, 3072
    s_add_u32 s46, s52, 12288
    buffer_load_dwordx4 v2, s[8:11], s46 offen lds
    s_add_u32 s46, s53, 0
    buffer_load_dwordx4 a[44:47], v3, s[12:15], s46 offen offset:3072
    s_add_u32 m0, s45, 16384
    s_add_u32 s46, s52, 65536
    buffer_load_dwordx4 v2, s[8:11], s46 offen lds
    s_add_u32 s46, s53, 4096
    buffer_load_dwordx4 a[48:51], v3, s[12:15], s46 offen offset:0
    s_add_u32 m0, s45, 17408
    s_add_u32 s46, s52, 69632
    buffer_load_dwordx4 v2, s[8:11], s46 offen lds
    s_add_u32 s46, s53, 4096
    buffer_load_dwordx4 a[52:55], v3, s[12:15], s46 offen offset:1024
    s_add_u32 m0, s45, 18432
    s_add_u32 s46, s52, 73728
    buffer_load_dwordx4 v2, s[8:11], s46 offen lds
    s_add_u32 s46, s53, 4096
    buffer_load_dwordx4 a[56:59], v3, s[12:15], s46 offen offset:2048
    s_add_u32 m0, s45, 19456
    s_add_u32 s46, s52, 77824
    buffer_load_dwordx4 v2, s[8:11], s46 offen lds
    s_add_u32 s46, s53, 4096
    buffer_load_dwordx4 a[60:63], v3, s[12:15], s46 offen offset:3072
    s_add_u32 m0, s45, 32768
    s_add_u32 s46, s52, 131072
    buffer_load_dwordx4 v2, s[8:11], s46 offen lds
    s_add_u32 s46, s53, 8192
    buffer_load_dwordx4 a[64:67], v3, s[12:15], s46 offen offset:0
    s_add_u32 m0, s45, 33792
    s_add_u32 s46, s52, 135168
    buffer_load_dwordx4 v2, s[8:11], s46 offen lds
    s_add_u32 s46, s53, 8192
    buffer_load_dwordx4 a[68:71], v3, s[12:15], s46 offen offset:1024
    s_add_u32 m0, s45, 34816
    s_add_u32 s46, s52, 139264
    buffer_load_dwordx4 v2, s[8:11], s46 offen lds
    s_add_u32 s46, s53, 8192
    buffer_load_dwordx4 a[72:75], v3, s[12:15], s46 offen offset:2048
    s_add_u32 m0, s45, 35840
    s_add_u32 s46, s52, 143360
    buffer_load_dwordx4 v2, s[8:11], s46 offen lds
    s_add_u32 s46, s53, 8192
    buffer_load_dwordx4 a[76:79], v3, s[12:15], s46 offen offset:3072
    s_add_u32 m0, s45, 49152
    s_add_u32 s46, s52, 196608
    buffer_load_dwordx4 v2, s[8:11], s46 offen lds
    s_add_u32 s46, s53, 12288
    buffer_load_dwordx4 a[80:83], v3, s[12:15], s46 offen offset:0
    s_add_u32 m0, s45, 50176
    s_add_u32 s46, s52, 200704
    buffer_load_dwordx4 v2, s[8:11], s46 offen lds
    s_add_u32 s46, s53, 12288
    buffer_load_dwordx4 a[84:87], v3, s[12:15], s46 offen offset:1024
    s_add_u32 m0, s45, 51200
    s_add_u32 s46, s52, 204800
    buffer_load_dwordx4 v2, s[8:11], s46 offen lds
    s_add_u32 s46, s53, 12288
    buffer_load_dwordx4 a[88:91], v3, s[12:15], s46 offen offset:2048
    s_add_u32 m0, s45, 52224
    s_add_u32 s46, s52, 208896
    buffer_load_dwordx4 v2, s[8:11], s46 offen lds
    s_add_u32 s46, s53, 12288
    buffer_load_dwordx4 a[92:95], v3, s[12:15], s46 offen offset:3072
    s_add_u32 m0, s45, 65536
    s_add_u32 s46, s52, 262144
    buffer_load_dwordx4 v2, s[8:11], s46 offen lds
    s_add_u32 s46, s53, 16384
    buffer_load_dwordx4 a[96:99], v3, s[12:15], s46 offen offset:0
    s_add_u32 m0, s45, 66560
    s_add_u32 s46, s52, 266240
    buffer_load_dwordx4 v2, s[8:11], s46 offen lds
    s_add_u32 s46, s53, 16384
    buffer_load_dwordx4 a[100:103], v3, s[12:15], s46 offen offset:1024
    s_add_u32 m0, s45, 67584
    s_add_u32 s46, s52, 270336
    buffer_load_dwordx4 v2, s[8:11], s46 offen lds
    s_add_u32 s46, s53, 16384
    buffer_load_dwordx4 a[104:107], v3, s[12:15], s46 offen offset:2048
    s_add_u32 m0, s45, 68608
    s_add_u32 s46, s52, 274432
    buffer_load_dwordx4 v2, s[8:11], s46 offen lds
    s_add_u32 s46, s53, 16384
    buffer_load_dwordx4 a[108:111], v3, s[12:15], s46 offen offset:3072
    s_add_u32 m0, s45, 81920
    s_add_u32 s46, s52, 327680
    buffer_load_dwordx4 v2, s[8:11], s46 offen lds
    s_add_u32 s46, s53, 20480
    buffer_load_dwordx4 a[112:115], v3, s[12:15], s46 offen offset:0
    s_add_u32 m0, s45, 82944
    s_add_u32 s46, s52, 331776
    buffer_load_dwordx4 v2, s[8:11], s46 offen lds
    s_add_u32 s46, s53, 20480
    buffer_load_dwordx4 a[116:119], v3, s[12:15], s46 offen offset:1024
    s_add_u32 m0, s45, 83968
    s_add_u32 s46, s52, 335872
    buffer_load_dwordx4 v2, s[8:11], s46 offen lds
    s_add_u32 s46, s53, 20480
    buffer_load_dwordx4 a[120:123], v3, s[12:15], s46 offen offset:2048
    s_add_u32 m0, s45, 84992
    s_add_u32 s46, s52, 339968
    buffer_load_dwordx4 v2, s[8:11], s46 offen lds
    s_add_u32 s46, s53, 20480
    buffer_load_dwordx4 a[124:127], v3, s[12:15], s46 offen offset:3072
    s_add_u32 m0, s45, 98304
    s_add_u32 s46, s52, 393216
    buffer_load_dwordx4 v2, s[8:11], s46 offen lds
    s_add_u32 s46, s53, 24576
    buffer_load_dwordx4 a[128:131], v3, s[12:15], s46 offen offset:0
    s_add_u32 m0, s45, 99328
    s_add_u32 s46, s52, 397312
    buffer_load_dwordx4 v2, s[8:11], s46 offen lds
    s_add_u32 s46, s53, 24576
    buffer_load_dwordx4 a[132:135], v3, s[12:15], s46 offen offset:1024
    s_add_u32 m0, s45, 100352
    s_add_u32 s46, s52, 401408
    buffer_load_dwordx4 v2, s[8:11], s46 offen lds
    s_add_u32 s46, s53, 24576
    buffer_load_dwordx4 a[136:139], v3, s[12:15], s46 offen offset:2048
    s_add_u32 m0, s45, 101376
    s_add_u32 s46, s52, 405504
    buffer_load_dwordx4 v2, s[8:11], s46 offen lds
    s_add_u32 s46, s53, 24576
    buffer_load_dwordx4 a[140:143], v3, s[12:15], s46 offen offset:3072
    s_waitcnt vmcnt(48)
    s_barrier
    ds_read_b64_tr_b16 a[0:1], v4 offset:0
    ds_read_b64_tr_b16 a[2:3], v4 offset:1024
    ds_read_b64_tr_b16 a[4:5], v5 offset:0
    ds_read_b64_tr_b16 a[6:7], v5 offset:1024
    ds_read_b64_tr_b16 a[8:9], v6 offset:0
    ds_read_b64_tr_b16 a[10:11], v6 offset:1024
    ds_read_b64_tr_b16 a[12:13], v7 offset:0
    ds_read_b64_tr_b16 a[14:15], v7 offset:1024
    ds_read_b64_tr_b16 a[16:17], v4 offset:4096
    ds_read_b64_tr_b16 a[18:19], v4 offset:5120
    ds_read_b64_tr_b16 a[20:21], v5 offset:4096
    ds_read_b64_tr_b16 a[22:23], v5 offset:5120
    ds_read_b64_tr_b16 a[24:25], v6 offset:4096
    ds_read_b64_tr_b16 a[26:27], v6 offset:5120
    ds_read_b64_tr_b16 a[28:29], v7 offset:4096
    ds_read_b64_tr_b16 a[30:31], v7 offset:5120
oproj_loop:
    s_waitcnt vmcnt(40)
    s_barrier
    s_waitcnt lgkmcnt(14)
    v_mfma_f32_32x32x16_bf16 v[32:47], a[0:3], a[32:35], v[32:47]
    ds_read_b64_tr_b16 a[0:1], v4 offset:8192
    ds_read_b64_tr_b16 a[2:3], v4 offset:9216
    s_waitcnt lgkmcnt(14)
    v_mfma_f32_32x32x16_bf16 v[48:63], a[4:7], a[32:35], v[48:63]
    ds_read_b64_tr_b16 a[4:5], v5 offset:8192
    ds_read_b64_tr_b16 a[6:7], v5 offset:9216
    s_add_u32 m0, s45, 114688
    s_add_u32 s46, s52, 458752
    buffer_load_dwordx4 v2, s[8:11], s46 offen lds
    s_waitcnt lgkmcnt(14)
    v_mfma_f32_32x32x16_bf16 v[64:79], a[8:11], a[32:35], v[64:79]
    ds_read_b64_tr_b16 a[8:9], v6 offset:8192
    ds_read_b64_tr_b16 a[10:11], v6 offset:9216
    s_waitcnt lgkmcnt(14)
    v_mfma_f32_32x32x16_bf16 v[80:95], a[12:15], a[32:35], v[80:95]
    ds_read_b64_tr_b16 a[12:13], v7 offset:8192
    ds_read_b64_tr_b16 a[14:15], v7 offset:9216
    s_add_u32 s46, s53, 28672
    buffer_load_dwordx4 a[144:147], v3, s[12:15], s46 offen offset:0
    s_waitcnt lgkmcnt(14)
    v_mfma_f32_32x32x16_bf16 v[32:47], a[16:19], a[36:39], v[32:47]
    ds_read_b64_tr_b16 a[16:17], v4 offset:12288
    ds_read_b64_tr_b16 a[18:19], v4 offset:13312
    s_waitcnt lgkmcnt(14)
    v_mfma_f32_32x32x16_bf16 v[48:63], a[20:23], a[36:39], v[48:63]
    ds_read_b64_tr_b16 a[20:21], v5 offset:12288
    ds_read_b64_tr_b16 a[22:23], v5 offset:13312
    s_add_u32 m0, s45, 115712
    s_add_u32 s46, s52, 462848
    buffer_load_dwordx4 v2, s[8:11], s46 offen lds
    s_waitcnt lgkmcnt(14)
    v_mfma_f32_32x32x16_bf16 v[64:79], a[24:27], a[36:39], v[64:79]
    ds_read_b64_tr_b16 a[24:25], v6 offset:12288
    ds_read_b64_tr_b16 a[26:27], v6 offset:13312
    s_waitcnt lgkmcnt(14)
    v_mfma_f32_32x32x16_bf16 v[80:95], a[28:31], a[36:39], v[80:95]
    ds_read_b64_tr_b16 a[28:29], v7 offset:12288
    ds_read_b64_tr_b16 a[30:31], v7 offset:13312
    s_add_u32 s46, s53, 28672
    buffer_load_dwordx4 a[148:151], v3, s[12:15], s46 offen offset:1024
    s_waitcnt lgkmcnt(14)
    v_mfma_f32_32x32x16_bf16 v[32:47], a[0:3], a[40:43], v[32:47]
    ds_read_b64_tr_b16 a[0:1], v4 offset:16384
    ds_read_b64_tr_b16 a[2:3], v4 offset:17408
    s_waitcnt lgkmcnt(14)
    v_mfma_f32_32x32x16_bf16 v[48:63], a[4:7], a[40:43], v[48:63]
    ds_read_b64_tr_b16 a[4:5], v5 offset:16384
    ds_read_b64_tr_b16 a[6:7], v5 offset:17408
    s_add_u32 m0, s45, 116736
    s_add_u32 s46, s52, 466944
    buffer_load_dwordx4 v2, s[8:11], s46 offen lds
    s_waitcnt lgkmcnt(14)
    v_mfma_f32_32x32x16_bf16 v[64:79], a[8:11], a[40:43], v[64:79]
    ds_read_b64_tr_b16 a[8:9], v6 offset:16384
    ds_read_b64_tr_b16 a[10:11], v6 offset:17408
    s_waitcnt lgkmcnt(14)
    v_mfma_f32_32x32x16_bf16 v[80:95], a[12:15], a[40:43], v[80:95]
    ds_read_b64_tr_b16 a[12:13], v7 offset:16384
    ds_read_b64_tr_b16 a[14:15], v7 offset:17408
    s_add_u32 s46, s53, 28672
    buffer_load_dwordx4 a[152:155], v3, s[12:15], s46 offen offset:2048
    s_waitcnt lgkmcnt(14)
    v_mfma_f32_32x32x16_bf16 v[32:47], a[16:19], a[44:47], v[32:47]
    ds_read_b64_tr_b16 a[16:17], v4 offset:20480
    ds_read_b64_tr_b16 a[18:19], v4 offset:21504
    s_waitcnt lgkmcnt(14)
    v_mfma_f32_32x32x16_bf16 v[48:63], a[20:23], a[44:47], v[48:63]
    ds_read_b64_tr_b16 a[20:21], v5 offset:20480
    ds_read_b64_tr_b16 a[22:23], v5 offset:21504
    s_add_u32 m0, s45, 117760
    s_add_u32 s46, s52, 471040
    buffer_load_dwordx4 v2, s[8:11], s46 offen lds
    s_waitcnt lgkmcnt(14)
    v_mfma_f32_32x32x16_bf16 v[64:79], a[24:27], a[44:47], v[64:79]
    ds_read_b64_tr_b16 a[24:25], v6 offset:20480
    ds_read_b64_tr_b16 a[26:27], v6 offset:21504
    s_waitcnt lgkmcnt(14)
    v_mfma_f32_32x32x16_bf16 v[80:95], a[28:31], a[44:47], v[80:95]
    ds_read_b64_tr_b16 a[28:29], v7 offset:20480
    ds_read_b64_tr_b16 a[30:31], v7 offset:21504
    s_add_u32 s46, s53, 28672
    buffer_load_dwordx4 a[156:159], v3, s[12:15], s46 offen offset:3072
    s_waitcnt vmcnt(40)
    s_barrier
    s_waitcnt lgkmcnt(14)
    v_mfma_f32_32x32x16_bf16 v[32:47], a[0:3], a[48:51], v[32:47]
    ds_read_b64_tr_b16 a[0:1], v4 offset:24576
    ds_read_b64_tr_b16 a[2:3], v4 offset:25600
    s_waitcnt lgkmcnt(14)
    v_mfma_f32_32x32x16_bf16 v[48:63], a[4:7], a[48:51], v[48:63]
    ds_read_b64_tr_b16 a[4:5], v5 offset:24576
    ds_read_b64_tr_b16 a[6:7], v5 offset:25600
    s_add_u32 m0, s45, 0
    s_add_u32 s46, s52, 524288
    buffer_load_dwordx4 v2, s[8:11], s46 offen lds
    s_waitcnt lgkmcnt(14)
    v_mfma_f32_32x32x16_bf16 v[64:79], a[8:11], a[48:51], v[64:79]
    ds_read_b64_tr_b16 a[8:9], v6 offset:24576
    ds_read_b64_tr_b16 a[10:11], v6 offset:25600
    s_waitcnt lgkmcnt(14)
    v_mfma_f32_32x32x16_bf16 v[80:95], a[12:15], a[48:51], v[80:95]
    ds_read_b64_tr_b16 a[12:13], v7 offset:24576
    ds_read_b64_tr_b16 a[14:15], v7 offset:25600
    s_add_u32 s46, s53, 32768
    buffer_load_dwordx4 a[32:35], v3, s[12:15], s46 offen offset:0
    s_waitcnt lgkmcnt(14)
    v_mfma_f32_32x32x16_bf16 v[32:47], a[16:19], a[52:55], v[32:47]
    ds_read_b64_tr_b16 a[16:17], v4 offset:28672
    ds_read_b64_tr_b16 a[18:19], v4 offset:29696
    s_waitcnt lgkmcnt(14)
    v_mfma_f32_32x32x16_bf16 v[48:63], a[20:23], a[52:55], v[48:63]
    ds_read_b64_tr_b16 a[20:21], v5 offset:28672
    ds_read_b64_tr_b16 a[22:23], v5 offset:29696
    s_add_u32 m0, s45, 1024
    s_add_u32 s46, s52, 528384
    buffer_load_dwordx4 v2, s[8:11], s46 offen lds
    s_waitcnt lgkmcnt(14)
    v_mfma_f32_32x32x16_bf16 v[64:79], a[24:27], a[52:55], v[64:79]
    ds_read_b64_tr_b16 a[24:25], v6 offset:28672
    ds_read_b64_tr_b16 a[26:27], v6 offset:29696
    s_waitcnt lgkmcnt(14)
    v_mfma_f32_32x32x16_bf16 v[80:95], a[28:31], a[52:55], v[80:95]
    ds_read_b64_tr_b16 a[28:29], v7 offset:28672
    ds_read_b64_tr_b16 a[30:31], v7 offset:29696
    s_add_u32 s46, s53, 32768
    buffer_load_dwordx4 a[36:39], v3, s[12:15], s46 offen offset:1024
    s_waitcnt lgkmcnt(14)
    v_mfma_f32_32x32x16_bf16 v[32:47], a[0:3], a[56:59], v[32:47]
    ds_read_b64_tr_b16 a[0:1], v4 offset:32768
    ds_read_b64_tr_b16 a[2:3], v4 offset:33792
    s_waitcnt lgkmcnt(14)
    v_mfma_f32_32x32x16_bf16 v[48:63], a[4:7], a[56:59], v[48:63]
    ds_read_b64_tr_b16 a[4:5], v5 offset:32768
    ds_read_b64_tr_b16 a[6:7], v5 offset:33792
    s_add_u32 m0, s45, 2048
    s_add_u32 s46, s52, 532480
    buffer_load_dwordx4 v2, s[8:11], s46 offen lds
    s_waitcnt lgkmcnt(14)
    v_mfma_f32_32x32x16_bf16 v[64:79], a[8:11], a[56:59], v[64:79]
    ds_read_b64_tr_b16 a[8:9], v6 offset:32768
    ds_read_b64_tr_b16 a[10:11], v6 offset:33792
    s_waitcnt lgkmcnt(14)
    v_mfma_f32_32x32x16_bf16 v[80:95], a[12:15], a[56:59], v[80:95]
    ds_read_b64_tr_b16 a[12:13], v7 offset:32768
    ds_read_b64_tr_b16 a[14:15], v7 offset:33792
    s_add_u32 s46, s53, 32768
    buffer_load_dwordx4 a[40:43], v3, s[12:15], s46 offen offset:2048
    s_waitcnt lgkmcnt(14)
    v_mfma_f32_32x32x16_bf16 v[32:47], a[16:19], a[60:63], v[32:47]
    ds_read_b64_tr_b16 a[16:17], v4 offset:36864
    ds_read_b64_tr_b16 a[18:19], v4 offset:37888
    s_waitcnt lgkmcnt(14)
    v_mfma_f32_32x32x16_bf16 v[48:63], a[20:23], a[60:63], v[48:63]
    ds_read_b64_tr_b16 a[20:21], v5 offset:36864
    ds_read_b64_tr_b16 a[22:23], v5 offset:37888
    s_add_u32 m0, s45, 3072
    s_add_u32 s46, s52, 536576
    buffer_load_dwordx4 v2, s[8:11], s46 offen lds
    s_waitcnt lgkmcnt(14)
    v_mfma_f32_32x32x16_bf16 v[64:79], a[24:27], a[60:63], v[64:79]
    ds_read_b64_tr_b16 a[24:25], v6 offset:36864
    ds_read_b64_tr_b16 a[26:27], v6 offset:37888
    s_waitcnt lgkmcnt(14)
    v_mfma_f32_32x32x16_bf16 v[80:95], a[28:31], a[60:63], v[80:95]
    ds_read_b64_tr_b16 a[28:29], v7 offset:36864
    ds_read_b64_tr_b16 a[30:31], v7 offset:37888
    s_add_u32 s46, s53, 32768
    buffer_load_dwordx4 a[44:47], v3, s[12:15], s46 offen offset:3072
    s_waitcnt vmcnt(40)
    s_barrier
    s_waitcnt lgkmcnt(14)
    v_mfma_f32_32x32x16_bf16 v[32:47], a[0:3], a[64:67], v[32:47]
    ds_read_b64_tr_b16 a[0:1], v4 offset:40960
    ds_read_b64_tr_b16 a[2:3], v4 offset:41984
    s_waitcnt lgkmcnt(14)
    v_mfma_f32_32x32x16_bf16 v[48:63], a[4:7], a[64:67], v[48:63]
    ds_read_b64_tr_b16 a[4:5], v5 offset:40960
    ds_read_b64_tr_b16 a[6:7], v5 offset:41984
    s_add_u32 m0, s45, 16384
    s_add_u32 s46, s52, 589824
    buffer_load_dwordx4 v2, s[8:11], s46 offen lds
    s_waitcnt lgkmcnt(14)
    v_mfma_f32_32x32x16_bf16 v[64:79], a[8:11], a[64:67], v[64:79]
    ds_read_b64_tr_b16 a[8:9], v6 offset:40960
    ds_read_b64_tr_b16 a[10:11], v6 offset:41984
    s_waitcnt lgkmcnt(14)
    v_mfma_f32_32x32x16_bf16 v[80:95], a[12:15], a[64:67], v[80:95]
    ds_read_b64_tr_b16 a[12:13], v7 offset:40960
    ds_read_b64_tr_b16 a[14:15], v7 offset:41984
    s_add_u32 s46, s53, 36864
    buffer_load_dwordx4 a[48:51], v3, s[12:15], s46 offen offset:0
    s_waitcnt lgkmcnt(14)
    v_mfma_f32_32x32x16_bf16 v[32:47], a[16:19], a[68:71], v[32:47]
    ds_read_b64_tr_b16 a[16:17], v4 offset:45056
    ds_read_b64_tr_b16 a[18:19], v4 offset:46080
    s_waitcnt lgkmcnt(14)
    v_mfma_f32_32x32x16_bf16 v[48:63], a[20:23], a[68:71], v[48:63]
    ds_read_b64_tr_b16 a[20:21], v5 offset:45056
    ds_read_b64_tr_b16 a[22:23], v5 offset:46080
    s_add_u32 m0, s45, 17408
    s_add_u32 s46, s52, 593920
    buffer_load_dwordx4 v2, s[8:11], s46 offen lds
    s_waitcnt lgkmcnt(14)
    v_mfma_f32_32x32x16_bf16 v[64:79], a[24:27], a[68:71], v[64:79]
    ds_read_b64_tr_b16 a[24:25], v6 offset:45056
    ds_read_b64_tr_b16 a[26:27], v6 offset:46080
    s_waitcnt lgkmcnt(14)
    v_mfma_f32_32x32x16_bf16 v[80:95], a[28:31], a[68:71], v[80:95]
    ds_read_b64_tr_b16 a[28:29], v7 offset:45056
    ds_read_b64_tr_b16 a[30:31], v7 offset:46080
    s_add_u32 s46, s53, 36864
    buffer_load_dwordx4 a[52:55], v3, s[12:15], s46 offen offset:1024
    s_waitcnt lgkmcnt(14)
    v_mfma_f32_32x32x16_bf16 v[32:47], a[0:3], a[72:75], v[32:47]
    ds_read_b64_tr_b16 a[0:1], v4 offset:49152
    ds_read_b64_tr_b16 a[2:3], v4 offset:50176
    s_waitcnt lgkmcnt(14)
    v_mfma_f32_32x32x16_bf16 v[48:63], a[4:7], a[72:75], v[48:63]
    ds_read_b64_tr_b16 a[4:5], v5 offset:49152
    ds_read_b64_tr_b16 a[6:7], v5 offset:50176
    s_add_u32 m0, s45, 18432
    s_add_u32 s46, s52, 598016
    buffer_load_dwordx4 v2, s[8:11], s46 offen lds
    s_waitcnt lgkmcnt(14)
    v_mfma_f32_32x32x16_bf16 v[64:79], a[8:11], a[72:75], v[64:79]
    ds_read_b64_tr_b16 a[8:9], v6 offset:49152
    ds_read_b64_tr_b16 a[10:11], v6 offset:50176
    s_waitcnt lgkmcnt(14)
    v_mfma_f32_32x32x16_bf16 v[80:95], a[12:15], a[72:75], v[80:95]
    ds_read_b64_tr_b16 a[12:13], v7 offset:49152
    ds_read_b64_tr_b16 a[14:15], v7 offset:50176
    s_add_u32 s46, s53, 36864
    buffer_load_dwordx4 a[56:59], v3, s[12:15], s46 offen offset:2048
    s_waitcnt lgkmcnt(14)
    v_mfma_f32_32x32x16_bf16 v[32:47], a[16:19], a[76:79], v[32:47]
    ds_read_b64_tr_b16 a[16:17], v4 offset:53248
    ds_read_b64_tr_b16 a[18:19], v4 offset:54272
    s_waitcnt lgkmcnt(14)
    v_mfma_f32_32x32x16_bf16 v[48:63], a[20:23], a[76:79], v[48:63]
    ds_read_b64_tr_b16 a[20:21], v5 offset:53248
    ds_read_b64_tr_b16 a[22:23], v5 offset:54272
    s_add_u32 m0, s45, 19456
    s_add_u32 s46, s52, 602112
    buffer_load_dwordx4 v2, s[8:11], s46 offen lds
    s_waitcnt lgkmcnt(14)
    v_mfma_f32_32x32x16_bf16 v[64:79], a[24:27], a[76:79], v[64:79]
    ds_read_b64_tr_b16 a[24:25], v6 offset:53248
    ds_read_b64_tr_b16 a[26:27], v6 offset:54272
    s_waitcnt lgkmcnt(14)
    v_mfma_f32_32x32x16_bf16 v[80:95], a[28:31], a[76:79], v[80:95]
    ds_read_b64_tr_b16 a[28:29], v7 offset:53248
    ds_read_b64_tr_b16 a[30:31], v7 offset:54272
    s_add_u32 s46, s53, 36864
    buffer_load_dwordx4 a[60:63], v3, s[12:15], s46 offen offset:3072
    s_waitcnt vmcnt(40)
    s_barrier
    s_waitcnt lgkmcnt(14)
    v_mfma_f32_32x32x16_bf16 v[32:47], a[0:3], a[80:83], v[32:47]
    ds_read_b64_tr_b16 a[0:1], v4 offset:57344
    ds_read_b64_tr_b16 a[2:3], v4 offset:58368
    s_waitcnt lgkmcnt(14)
    v_mfma_f32_32x32x16_bf16 v[48:63], a[4:7], a[80:83], v[48:63]
    ds_read_b64_tr_b16 a[4:5], v5 offset:57344
    ds_read_b64_tr_b16 a[6:7], v5 offset:58368
    s_add_u32 m0, s45, 32768
    s_add_u32 s46, s52, 655360
    buffer_load_dwordx4 v2, s[8:11], s46 offen lds
    s_waitcnt lgkmcnt(14)
    v_mfma_f32_32x32x16_bf16 v[64:79], a[8:11], a[80:83], v[64:79]
    ds_read_b64_tr_b16 a[8:9], v6 offset:57344
    ds_read_b64_tr_b16 a[10:11], v6 offset:58368
    s_waitcnt lgkmcnt(14)
    v_mfma_f32_32x32x16_bf16 v[80:95], a[12:15], a[80:83], v[80:95]
    ds_read_b64_tr_b16 a[12:13], v7 offset:57344
    ds_read_b64_tr_b16 a[14:15], v7 offset:58368
    s_add_u32 s46, s53, 40960
    buffer_load_dwordx4 a[64:67], v3, s[12:15], s46 offen offset:0
    s_waitcnt lgkmcnt(14)
    v_mfma_f32_32x32x16_bf16 v[32:47], a[16:19], a[84:87], v[32:47]
    ds_read_b64_tr_b16 a[16:17], v4 offset:61440
    ds_read_b64_tr_b16 a[18:19], v4 offset:62464
    s_waitcnt lgkmcnt(14)
    v_mfma_f32_32x32x16_bf16 v[48:63], a[20:23], a[84:87], v[48:63]
    ds_read_b64_tr_b16 a[20:21], v5 offset:61440
    ds_read_b64_tr_b16 a[22:23], v5 offset:62464
    s_add_u32 m0, s45, 33792
    s_add_u32 s46, s52, 659456
    buffer_load_dwordx4 v2, s[8:11], s46 offen lds
    s_waitcnt lgkmcnt(14)
    v_mfma_f32_32x32x16_bf16 v[64:79], a[24:27], a[84:87], v[64:79]
    ds_read_b64_tr_b16 a[24:25], v6 offset:61440
    ds_read_b64_tr_b16 a[26:27], v6 offset:62464
    s_waitcnt lgkmcnt(14)
    v_mfma_f32_32x32x16_bf16 v[80:95], a[28:31], a[84:87], v[80:95]
    ds_read_b64_tr_b16 a[28:29], v7 offset:61440
    ds_read_b64_tr_b16 a[30:31], v7 offset:62464
    s_add_u32 s46, s53, 40960
    buffer_load_dwordx4 a[68:71], v3, s[12:15], s46 offen offset:1024
    s_waitcnt lgkmcnt(14)
    v_mfma_f32_32x32x16_bf16 v[32:47], a[0:3], a[88:91], v[32:47]
    ds_read_b64_tr_b16 a[0:1], v8 offset:0
    ds_read_b64_tr_b16 a[2:3], v8 offset:1024
    s_waitcnt lgkmcnt(14)
    v_mfma_f32_32x32x16_bf16 v[48:63], a[4:7], a[88:91], v[48:63]
    ds_read_b64_tr_b16 a[4:5], v9 offset:0
    ds_read_b64_tr_b16 a[6:7], v9 offset:1024
    s_add_u32 m0, s45, 34816
    s_add_u32 s46, s52, 663552
    buffer_load_dwordx4 v2, s[8:11], s46 offen lds
    s_waitcnt lgkmcnt(14)
    v_mfma_f32_32x32x16_bf16 v[64:79], a[8:11], a[88:91], v[64:79]
    ds_read_b64_tr_b16 a[8:9], v10 offset:0
    ds_read_b64_tr_b16 a[10:11], v10 offset:1024
    s_waitcnt lgkmcnt(14)
    v_mfma_f32_32x32x16_bf16 v[80:95], a[12:15], a[88:91], v[80:95]
    ds_read_b64_tr_b16 a[12:13], v11 offset:0
    ds_read_b64_tr_b16 a[14:15], v11 offset:1024
    s_add_u32 s46, s53, 40960
    buffer_load_dwordx4 a[72:75], v3, s[12:15], s46 offen offset:2048
    s_waitcnt lgkmcnt(14)
    v_mfma_f32_32x32x16_bf16 v[32:47], a[16:19], a[92:95], v[32:47]
    ds_read_b64_tr_b16 a[16:17], v8 offset:4096
    ds_read_b64_tr_b16 a[18:19], v8 offset:5120
    s_waitcnt lgkmcnt(14)
    v_mfma_f32_32x32x16_bf16 v[48:63], a[20:23], a[92:95], v[48:63]
    ds_read_b64_tr_b16 a[20:21], v9 offset:4096
    ds_read_b64_tr_b16 a[22:23], v9 offset:5120
    s_add_u32 m0, s45, 35840
    s_add_u32 s46, s52, 667648
    buffer_load_dwordx4 v2, s[8:11], s46 offen lds
    s_waitcnt lgkmcnt(14)
    v_mfma_f32_32x32x16_bf16 v[64:79], a[24:27], a[92:95], v[64:79]
    ds_read_b64_tr_b16 a[24:25], v10 offset:4096
    ds_read_b64_tr_b16 a[26:27], v10 offset:5120
    s_waitcnt lgkmcnt(14)
    v_mfma_f32_32x32x16_bf16 v[80:95], a[28:31], a[92:95], v[80:95]
    ds_read_b64_tr_b16 a[28:29], v11 offset:4096
    ds_read_b64_tr_b16 a[30:31], v11 offset:5120
    s_add_u32 s46, s53, 40960
    buffer_load_dwordx4 a[76:79], v3, s[12:15], s46 offen offset:3072
    s_waitcnt vmcnt(40)
    s_barrier
    s_waitcnt lgkmcnt(14)
    v_mfma_f32_32x32x16_bf16 v[32:47], a[0:3], a[96:99], v[32:47]
    ds_read_b64_tr_b16 a[0:1], v8 offset:8192
    ds_read_b64_tr_b16 a[2:3], v8 offset:9216
    s_waitcnt lgkmcnt(14)
    v_mfma_f32_32x32x16_bf16 v[48:63], a[4:7], a[96:99], v[48:63]
    ds_read_b64_tr_b16 a[4:5], v9 offset:8192
    ds_read_b64_tr_b16 a[6:7], v9 offset:9216
    s_add_u32 m0, s45, 49152
    s_add_u32 s46, s52, 720896
    buffer_load_dwordx4 v2, s[8:11], s46 offen lds
    s_waitcnt lgkmcnt(14)
    v_mfma_f32_32x32x16_bf16 v[64:79], a[8:11], a[96:99], v[64:79]
    ds_read_b64_tr_b16 a[8:9], v10 offset:8192
    ds_read_b64_tr_b16 a[10:11], v10 offset:9216
    s_waitcnt lgkmcnt(14)
    v_mfma_f32_32x32x16_bf16 v[80:95], a[12:15], a[96:99], v[80:95]
    ds_read_b64_tr_b16 a[12:13], v11 offset:8192
    ds_read_b64_tr_b16 a[14:15], v11 offset:9216
    s_add_u32 s46, s53, 45056
    buffer_load_dwordx4 a[80:83], v3, s[12:15], s46 offen offset:0
    s_waitcnt lgkmcnt(14)
    v_mfma_f32_32x32x16_bf16 v[32:47], a[16:19], a[100:103], v[32:47]
    ds_read_b64_tr_b16 a[16:17], v8 offset:12288
    ds_read_b64_tr_b16 a[18:19], v8 offset:13312
    s_waitcnt lgkmcnt(14)
    v_mfma_f32_32x32x16_bf16 v[48:63], a[20:23], a[100:103], v[48:63]
    ds_read_b64_tr_b16 a[20:21], v9 offset:12288
    ds_read_b64_tr_b16 a[22:23], v9 offset:13312
    s_add_u32 m0, s45, 50176
    s_add_u32 s46, s52, 724992
    buffer_load_dwordx4 v2, s[8:11], s46 offen lds
    s_waitcnt lgkmcnt(14)
    v_mfma_f32_32x32x16_bf16 v[64:79], a[24:27], a[100:103], v[64:79]
    ds_read_b64_tr_b16 a[24:25], v10 offset:12288
    ds_read_b64_tr_b16 a[26:27], v10 offset:13312
    s_waitcnt lgkmcnt(14)
    v_mfma_f32_32x32x16_bf16 v[80:95], a[28:31], a[100:103], v[80:95]
    ds_read_b64_tr_b16 a[28:29], v11 offset:12288
    ds_read_b64_tr_b16 a[30:31], v11 offset:13312
    s_add_u32 s46, s53, 45056
    buffer_load_dwordx4 a[84:87], v3, s[12:15], s46 offen offset:1024
    s_waitcnt lgkmcnt(14)
    v_mfma_f32_32x32x16_bf16 v[32:47], a[0:3], a[104:107], v[32:47]
    ds_read_b64_tr_b16 a[0:1], v8 offset:16384
    ds_read_b64_tr_b16 a[2:3], v8 offset:17408
    s_waitcnt lgkmcnt(14)
    v_mfma_f32_32x32x16_bf16 v[48:63], a[4:7], a[104:107], v[48:63]
    ds_read_b64_tr_b16 a[4:5], v9 offset:16384
    ds_read_b64_tr_b16 a[6:7], v9 offset:17408
    s_add_u32 m0, s45, 51200
    s_add_u32 s46, s52, 729088
    buffer_load_dwordx4 v2, s[8:11], s46 offen lds
    s_waitcnt lgkmcnt(14)
    v_mfma_f32_32x32x16_bf16 v[64:79], a[8:11], a[104:107], v[64:79]
    ds_read_b64_tr_b16 a[8:9], v10 offset:16384
    ds_read_b64_tr_b16 a[10:11], v10 offset:17408
    s_waitcnt lgkmcnt(14)
    v_mfma_f32_32x32x16_bf16 v[80:95], a[12:15], a[104:107], v[80:95]
    ds_read_b64_tr_b16 a[12:13], v11 offset:16384
    ds_read_b64_tr_b16 a[14:15], v11 offset:17408
    s_add_u32 s46, s53, 45056
    buffer_load_dwordx4 a[88:91], v3, s[12:15], s46 offen offset:2048
    s_waitcnt lgkmcnt(14)
    v_mfma_f32_32x32x16_bf16 v[32:47], a[16:19], a[108:111], v[32:47]
    ds_read_b64_tr_b16 a[16:17], v8 offset:20480
    ds_read_b64_tr_b16 a[18:19], v8 offset:21504
    s_waitcnt lgkmcnt(14)
    v_mfma_f32_32x32x16_bf16 v[48:63], a[20:23], a[108:111], v[48:63]
    ds_read_b64_tr_b16 a[20:21], v9 offset:20480
    ds_read_b64_tr_b16 a[22:23], v9 offset:21504
    s_add_u32 m0, s45, 52224
    s_add_u32 s46, s52, 733184
    buffer_load_dwordx4 v2, s[8:11], s46 offen lds
    s_waitcnt lgkmcnt(14)
    v_mfma_f32_32x32x16_bf16 v[64:79], a[24:27], a[108:111], v[64:79]
    ds_read_b64_tr_b16 a[24:25], v10 offset:20480
    ds_read_b64_tr_b16 a[26:27], v10 offset:21504
    s_waitcnt lgkmcnt(14)
    v_mfma_f32_32x32x16_bf16 v[80:95], a[28:31], a[108:111], v[80:95]
    ds_read_b64_tr_b16 a[28:29], v11 offset:20480
    ds_read_b64_tr_b16 a[30:31], v11 offset:21504
    s_add_u32 s46, s53, 45056
    buffer_load_dwordx4 a[92:95], v3, s[12:15], s46 offen offset:3072
    s_waitcnt vmcnt(40)
    s_barrier
    s_waitcnt lgkmcnt(14)
    v_mfma_f32_32x32x16_bf16 v[32:47], a[0:3], a[112:115], v[32:47]
    ds_read_b64_tr_b16 a[0:1], v8 offset:24576
    ds_read_b64_tr_b16 a[2:3], v8 offset:25600
    s_waitcnt lgkmcnt(14)
    v_mfma_f32_32x32x16_bf16 v[48:63], a[4:7], a[112:115], v[48:63]
    ds_read_b64_tr_b16 a[4:5], v9 offset:24576
    ds_read_b64_tr_b16 a[6:7], v9 offset:25600
    s_add_u32 m0, s45, 65536
    s_add_u32 s46, s52, 786432
    buffer_load_dwordx4 v2, s[8:11], s46 offen lds
    s_waitcnt lgkmcnt(14)
    v_mfma_f32_32x32x16_bf16 v[64:79], a[8:11], a[112:115], v[64:79]
    ds_read_b64_tr_b16 a[8:9], v10 offset:24576
    ds_read_b64_tr_b16 a[10:11], v10 offset:25600
    s_waitcnt lgkmcnt(14)
    v_mfma_f32_32x32x16_bf16 v[80:95], a[12:15], a[112:115], v[80:95]
    ds_read_b64_tr_b16 a[12:13], v11 offset:24576
    ds_read_b64_tr_b16 a[14:15], v11 offset:25600
    s_add_u32 s46, s53, 49152
    buffer_load_dwordx4 a[96:99], v3, s[12:15], s46 offen offset:0
    s_waitcnt lgkmcnt(14)
    v_mfma_f32_32x32x16_bf16 v[32:47], a[16:19], a[116:119], v[32:47]
    ds_read_b64_tr_b16 a[16:17], v8 offset:28672
    ds_read_b64_tr_b16 a[18:19], v8 offset:29696
    s_waitcnt lgkmcnt(14)
    v_mfma_f32_32x32x16_bf16 v[48:63], a[20:23], a[116:119], v[48:63]
    ds_read_b64_tr_b16 a[20:21], v9 offset:28672
    ds_read_b64_tr_b16 a[22:23], v9 offset:29696
    s_add_u32 m0, s45, 66560
    s_add_u32 s46, s52, 790528
    buffer_load_dwordx4 v2, s[8:11], s46 offen lds
    s_waitcnt lgkmcnt(14)
    v_mfma_f32_32x32x16_bf16 v[64:79], a[24:27], a[116:119], v[64:79]
    ds_read_b64_tr_b16 a[24:25], v10 offset:28672
    ds_read_b64_tr_b16 a[26:27], v10 offset:29696
    s_waitcnt lgkmcnt(14)
    v_mfma_f32_32x32x16_bf16 v[80:95], a[28:31], a[116:119], v[80:95]
    ds_read_b64_tr_b16 a[28:29], v11 offset:28672
    ds_read_b64_tr_b16 a[30:31], v11 offset:29696
    s_add_u32 s46, s53, 49152
    buffer_load_dwordx4 a[100:103], v3, s[12:15], s46 offen offset:1024
    s_waitcnt lgkmcnt(14)
    v_mfma_f32_32x32x16_bf16 v[32:47], a[0:3], a[120:123], v[32:47]
    ds_read_b64_tr_b16 a[0:1], v8 offset:32768
    ds_read_b64_tr_b16 a[2:3], v8 offset:33792
    s_waitcnt lgkmcnt(14)
    v_mfma_f32_32x32x16_bf16 v[48:63], a[4:7], a[120:123], v[48:63]
    ds_read_b64_tr_b16 a[4:5], v9 offset:32768
    ds_read_b64_tr_b16 a[6:7], v9 offset:33792
    s_add_u32 m0, s45, 67584
    s_add_u32 s46, s52, 794624
    buffer_load_dwordx4 v2, s[8:11], s46 offen lds
    s_waitcnt lgkmcnt(14)
    v_mfma_f32_32x32x16_bf16 v[64:79], a[8:11], a[120:123], v[64:79]
    ds_read_b64_tr_b16 a[8:9], v10 offset:32768
    ds_read_b64_tr_b16 a[10:11], v10 offset:33792
    s_waitcnt lgkmcnt(14)
    v_mfma_f32_32x32x16_bf16 v[80:95], a[12:15], a[120:123], v[80:95]
    ds_read_b64_tr_b16 a[12:13], v11 offset:32768
    ds_read_b64_tr_b16 a[14:15], v11 offset:33792
    s_add_u32 s46, s53, 49152
    buffer_load_dwordx4 a[104:107], v3, s[12:15], s46 offen offset:2048
    s_waitcnt lgkmcnt(14)
    v_mfma_f32_32x32x16_bf16 v[32:47], a[16:19], a[124:127], v[32:47]
    ds_read_b64_tr_b16 a[16:17], v8 offset:36864
    ds_read_b64_tr_b16 a[18:19], v8 offset:37888
    s_waitcnt lgkmcnt(14)
    v_mfma_f32_32x32x16_bf16 v[48:63], a[20:23], a[124:127], v[48:63]
    ds_read_b64_tr_b16 a[20:21], v9 offset:36864
    ds_read_b64_tr_b16 a[22:23], v9 offset:37888
    s_add_u32 m0, s45, 68608
    s_add_u32 s46, s52, 798720
    buffer_load_dwordx4 v2, s[8:11], s46 offen lds
    s_waitcnt lgkmcnt(14)
    v_mfma_f32_32x32x16_bf16 v[64:79], a[24:27], a[124:127], v[64:79]
    ds_read_b64_tr_b16 a[24:25], v10 offset:36864
    ds_read_b64_tr_b16 a[26:27], v10 offset:37888
    s_waitcnt lgkmcnt(14)
    v_mfma_f32_32x32x16_bf16 v[80:95], a[28:31], a[124:127], v[80:95]
    ds_read_b64_tr_b16 a[28:29], v11 offset:36864
    ds_read_b64_tr_b16 a[30:31], v11 offset:37888
    s_add_u32 s46, s53, 49152
    buffer_load_dwordx4 a[108:111], v3, s[12:15], s46 offen offset:3072
    s_waitcnt vmcnt(40)
    s_barrier
    s_waitcnt lgkmcnt(14)
    v_mfma_f32_32x32x16_bf16 v[32:47], a[0:3], a[128:131], v[32:47]
    ds_read_b64_tr_b16 a[0:1], v8 offset:40960
    ds_read_b64_tr_b16 a[2:3], v8 offset:41984
    s_waitcnt lgkmcnt(14)
    v_mfma_f32_32x32x16_bf16 v[48:63], a[4:7], a[128:131], v[48:63]
    ds_read_b64_tr_b16 a[4:5], v9 offset:40960
    ds_read_b64_tr_b16 a[6:7], v9 offset:41984
    s_add_u32 m0, s45, 81920
    s_add_u32 s46, s52, 851968
    buffer_load_dwordx4 v2, s[8:11], s46 offen lds
    s_waitcnt lgkmcnt(14)
    v_mfma_f32_32x32x16_bf16 v[64:79], a[8:11], a[128:131], v[64:79]
    ds_read_b64_tr_b16 a[8:9], v10 offset:40960
    ds_read_b64_tr_b16 a[10:11], v10 offset:41984
    s_waitcnt lgkmcnt(14)
    v_mfma_f32_32x32x16_bf16 v[80:95], a[12:15], a[128:131], v[80:95]
    ds_read_b64_tr_b16 a[12:13], v11 offset:40960
    ds_read_b64_tr_b16 a[14:15], v11 offset:41984
    s_add_u32 s46, s53, 53248
    buffer_load_dwordx4 a[112:115], v3, s[12:15], s46 offen offset:0
    s_waitcnt lgkmcnt(14)
    v_mfma_f32_32x32x16_bf16 v[32:47], a[16:19], a[132:135], v[32:47]
    ds_read_b64_tr_b16 a[16:17], v8 offset:45056
    ds_read_b64_tr_b16 a[18:19], v8 offset:46080
    s_waitcnt lgkmcnt(14)
    v_mfma_f32_32x32x16_bf16 v[48:63], a[20:23], a[132:135], v[48:63]
    ds_read_b64_tr_b16 a[20:21], v9 offset:45056
    ds_read_b64_tr_b16 a[22:23], v9 offset:46080
    s_add_u32 m0, s45, 82944
    s_add_u32 s46, s52, 856064
    buffer_load_dwordx4 v2, s[8:11], s46 offen lds
    s_waitcnt lgkmcnt(14)
    v_mfma_f32_32x32x16_bf16 v[64:79], a[24:27], a[132:135], v[64:79]
    ds_read_b64_tr_b16 a[24:25], v10 offset:45056
    ds_read_b64_tr_b16 a[26:27], v10 offset:46080
    s_waitcnt lgkmcnt(14)
    v_mfma_f32_32x32x16_bf16 v[80:95], a[28:31], a[132:135], v[80:95]
    ds_read_b64_tr_b16 a[28:29], v11 offset:45056
    ds_read_b64_tr_b16 a[30:31], v11 offset:46080
    s_add_u32 s46, s53, 53248
    buffer_load_dwordx4 a[116:119], v3, s[12:15], s46 offen offset:1024
    s_waitcnt lgkmcnt(14)
    v_mfma_f32_32x32x16_bf16 v[32:47], a[0:3], a[136:139], v[32:47]
    ds_read_b64_tr_b16 a[0:1], v8 offset:49152
    ds_read_b64_tr_b16 a[2:3], v8 offset:50176
    s_waitcnt lgkmcnt(14)
    v_mfma_f32_32x32x16_bf16 v[48:63], a[4:7], a[136:139], v[48:63]
    ds_read_b64_tr_b16 a[4:5], v9 offset:49152
    ds_read_b64_tr_b16 a[6:7], v9 offset:50176
    s_add_u32 m0, s45, 83968
    s_add_u32 s46, s52, 860160
    buffer_load_dwordx4 v2, s[8:11], s46 offen lds
    s_waitcnt lgkmcnt(14)
    v_mfma_f32_32x32x16_bf16 v[64:79], a[8:11], a[136:139], v[64:79]
    ds_read_b64_tr_b16 a[8:9], v10 offset:49152
    ds_read_b64_tr_b16 a[10:11], v10 offset:50176
    s_waitcnt lgkmcnt(14)
    v_mfma_f32_32x32x16_bf16 v[80:95], a[12:15], a[136:139], v[80:95]
    ds_read_b64_tr_b16 a[12:13], v11 offset:49152
    ds_read_b64_tr_b16 a[14:15], v11 offset:50176
    s_add_u32 s46, s53, 53248
    buffer_load_dwordx4 a[120:123], v3, s[12:15], s46 offen offset:2048
    s_waitcnt lgkmcnt(14)
    v_mfma_f32_32x32x16_bf16 v[32:47], a[16:19], a[140:143], v[32:47]
    ds_read_b64_tr_b16 a[16:17], v8 offset:53248
    ds_read_b64_tr_b16 a[18:19], v8 offset:54272
    s_waitcnt lgkmcnt(14)
    v_mfma_f32_32x32x16_bf16 v[48:63], a[20:23], a[140:143], v[48:63]
    ds_read_b64_tr_b16 a[20:21], v9 offset:53248
    ds_read_b64_tr_b16 a[22:23], v9 offset:54272
    s_add_u32 m0, s45, 84992
    s_add_u32 s46, s52, 864256
    buffer_load_dwordx4 v2, s[8:11], s46 offen lds
    s_waitcnt lgkmcnt(14)
    v_mfma_f32_32x32x16_bf16 v[64:79], a[24:27], a[140:143], v[64:79]
    ds_read_b64_tr_b16 a[24:25], v10 offset:53248
    ds_read_b64_tr_b16 a[26:27], v10 offset:54272
    s_waitcnt lgkmcnt(14)
    v_mfma_f32_32x32x16_bf16 v[80:95], a[28:31], a[140:143], v[80:95]
    ds_read_b64_tr_b16 a[28:29], v11 offset:53248
    ds_read_b64_tr_b16 a[30:31], v11 offset:54272
    s_add_u32 s46, s53, 53248
    buffer_load_dwordx4 a[124:127], v3, s[12:15], s46 offen offset:3072
    s_waitcnt vmcnt(40)
    s_barrier
    s_waitcnt lgkmcnt(14)
    v_mfma_f32_32x32x16_bf16 v[32:47], a[0:3], a[144:147], v[32:47]
    ds_read_b64_tr_b16 a[0:1], v8 offset:57344
    ds_read_b64_tr_b16 a[2:3], v8 offset:58368
    s_waitcnt lgkmcnt(14)
    v_mfma_f32_32x32x16_bf16 v[48:63], a[4:7], a[144:147], v[48:63]
    ds_read_b64_tr_b16 a[4:5], v9 offset:57344
    ds_read_b64_tr_b16 a[6:7], v9 offset:58368
    s_add_u32 m0, s45, 98304
    s_add_u32 s46, s52, 917504
    buffer_load_dwordx4 v2, s[8:11], s46 offen lds
    s_waitcnt lgkmcnt(14)
    v_mfma_f32_32x32x16_bf16 v[64:79], a[8:11], a[144:147], v[64:79]
    ds_read_b64_tr_b16 a[8:9], v10 offset:57344
    ds_read_b64_tr_b16 a[10:11], v10 offset:58368
    s_waitcnt lgkmcnt(14)
    v_mfma_f32_32x32x16_bf16 v[80:95], a[12:15], a[144:147], v[80:95]
    ds_read_b64_tr_b16 a[12:13], v11 offset:57344
    ds_read_b64_tr_b16 a[14:15], v11 offset:58368
    s_add_u32 s46, s53, 57344
    buffer_load_dwordx4 a[128:131], v3, s[12:15], s46 offen offset:0
    s_waitcnt lgkmcnt(14)
    v_mfma_f32_32x32x16_bf16 v[32:47], a[16:19], a[148:151], v[32:47]
    ds_read_b64_tr_b16 a[16:17], v8 offset:61440
    ds_read_b64_tr_b16 a[18:19], v8 offset:62464
    s_waitcnt lgkmcnt(14)
    v_mfma_f32_32x32x16_bf16 v[48:63], a[20:23], a[148:151], v[48:63]
    ds_read_b64_tr_b16 a[20:21], v9 offset:61440
    ds_read_b64_tr_b16 a[22:23], v9 offset:62464
    s_add_u32 m0, s45, 99328
    s_add_u32 s46, s52, 921600
    buffer_load_dwordx4 v2, s[8:11], s46 offen lds
    s_waitcnt lgkmcnt(14)
    v_mfma_f32_32x32x16_bf16 v[64:79], a[24:27], a[148:151], v[64:79]
    ds_read_b64_tr_b16 a[24:25], v10 offset:61440
    ds_read_b64_tr_b16 a[26:27], v10 offset:62464
    s_waitcnt lgkmcnt(14)
    v_mfma_f32_32x32x16_bf16 v[80:95], a[28:31], a[148:151], v[80:95]
    ds_read_b64_tr_b16 a[28:29], v11 offset:61440
    ds_read_b64_tr_b16 a[30:31], v11 offset:62464
    s_add_u32 s46, s53, 57344
    buffer_load_dwordx4 a[132:135], v3, s[12:15], s46 offen offset:1024
    s_waitcnt lgkmcnt(14)
    v_mfma_f32_32x32x16_bf16 v[32:47], a[0:3], a[152:155], v[32:47]
    ds_read_b64_tr_b16 a[0:1], v4 offset:0
    ds_read_b64_tr_b16 a[2:3], v4 offset:1024
    s_waitcnt lgkmcnt(14)
    v_mfma_f32_32x32x16_bf16 v[48:63], a[4:7], a[152:155], v[48:63]
    ds_read_b64_tr_b16 a[4:5], v5 offset:0
    ds_read_b64_tr_b16 a[6:7], v5 offset:1024
    s_add_u32 m0, s45, 100352
    s_add_u32 s46, s52, 925696
    buffer_load_dwordx4 v2, s[8:11], s46 offen lds
    s_waitcnt lgkmcnt(14)
    v_mfma_f32_32x32x16_bf16 v[64:79], a[8:11], a[152:155], v[64:79]
    ds_read_b64_tr_b16 a[8:9], v6 offset:0
    ds_read_b64_tr_b16 a[10:11], v6 offset:1024
    s_waitcnt lgkmcnt(14)
    v_mfma_f32_32x32x16_bf16 v[80:95], a[12:15], a[152:155], v[80:95]
    ds_read_b64_tr_b16 a[12:13], v7 offset:0
    ds_read_b64_tr_b16 a[14:15], v7 offset:1024
    s_add_u32 s46, s53, 57344
    buffer_load_dwordx4 a[136:139], v3, s[12:15], s46 offen offset:2048
    s_waitcnt lgkmcnt(14)
    v_mfma_f32_32x32x16_bf16 v[32:47], a[16:19], a[156:159], v[32:47]
    ds_read_b64_tr_b16 a[16:17], v4 offset:4096
    ds_read_b64_tr_b16 a[18:19], v4 offset:5120
    s_waitcnt lgkmcnt(14)
    v_mfma_f32_32x32x16_bf16 v[48:63], a[20:23], a[156:159], v[48:63]
    ds_read_b64_tr_b16 a[20:21], v5 offset:4096
    ds_read_b64_tr_b16 a[22:23], v5 offset:5120
    s_add_u32 m0, s45, 101376
    s_add_u32 s46, s52, 929792
    buffer_load_dwordx4 v2, s[8:11], s46 offen lds
    s_waitcnt lgkmcnt(14)
    v_mfma_f32_32x32x16_bf16 v[64:79], a[24:27], a[156:159], v[64:79]
    ds_read_b64_tr_b16 a[24:25], v6 offset:4096
    ds_read_b64_tr_b16 a[26:27], v6 offset:5120
    s_waitcnt lgkmcnt(14)
    v_mfma_f32_32x32x16_bf16 v[80:95], a[28:31], a[156:159], v[80:95]
    ds_read_b64_tr_b16 a[28:29], v7 offset:4096
    ds_read_b64_tr_b16 a[30:31], v7 offset:5120
    s_add_u32 s46, s53, 57344
    buffer_load_dwordx4 a[140:143], v3, s[12:15], s46 offen offset:3072
    s_add_u32 s52, s52, 524288
    s_add_u32 s53, s53, 32768
    s_add_u32 s51, s51, 1
    s_cmp_lt_u32 s51, 4
    s_cbranch_scc1 oproj_loop
    s_nop 15
    s_cmp_eq_u32 s50, 0
    s_cbranch_scc1 oproj_send_hi
    s_mov_b32 s46, 4096
    buffer_store_dwordx4 v[32:35], v3, s[20:23], 0 offen offset:0 sc1
    buffer_store_dwordx4 v[36:39], v3, s[20:23], 0 offen offset:1024 sc1
    buffer_store_dwordx4 v[40:43], v3, s[20:23], 0 offen offset:2048 sc1
    buffer_store_dwordx4 v[44:47], v3, s[20:23], 0 offen offset:3072 sc1
    buffer_store_dwordx4 v[48:51], v3, s[20:23], s46 offen offset:0 sc1
    buffer_store_dwordx4 v[52:55], v3, s[20:23], s46 offen offset:1024 sc1
    buffer_store_dwordx4 v[56:59], v3, s[20:23], s46 offen offset:2048 sc1
    buffer_store_dwordx4 v[60:63], v3, s[20:23], s46 offen offset:3072 sc1
    s_nop 1
    v_mov_b32 v32, v64
    v_mov_b32 v33, v65
    v_mov_b32 v34, v66
    v_mov_b32 v35, v67
    v_mov_b32 v36, v68
    v_mov_b32 v37, v69
    v_mov_b32 v38, v70
    v_mov_b32 v39, v71
    v_mov_b32 v40, v72
    v_mov_b32 v41, v73
    v_mov_b32 v42, v74
    v_mov_b32 v43, v75
    v_mov_b32 v44, v76
    v_mov_b32 v45, v77
    v_mov_b32 v46, v78
    v_mov_b32 v47, v79
    v_mov_b32 v48, v80
    v_mov_b32 v49, v81
    v_mov_b32 v50, v82
    v_mov_b32 v51, v83
    v_mov_b32 v52, v84
    v_mov_b32 v53, v85
    v_mov_b32 v54, v86
    v_mov_b32 v55, v87
    v_mov_b32 v56, v88
    v_mov_b32 v57, v89
    v_mov_b32 v58, v90
    v_mov_b32 v59, v91
    v_mov_b32 v60, v92
    v_mov_b32 v61, v93
    v_mov_b32 v62, v94
    v_mov_b32 v63, v95
    s_branch oproj_sent
oproj_send_hi:
    s_mov_b32 s46, 4096
    buffer_store_dwordx4 v[64:67], v3, s[20:23], 0 offen offset:0 sc1
    buffer_store_dwordx4 v[68:71], v3, s[20:23], 0 offen offset:1024 sc1
    buffer_store_dwordx4 v[72:75], v3, s[20:23], 0 offen offset:2048 sc1
    buffer_store_dwordx4 v[76:79], v3, s[20:23], 0 offen offset:3072 sc1
    buffer_store_dwordx4 v[80:83], v3, s[20:23], s46 offen offset:0 sc1
    buffer_store_dwordx4 v[84:87], v3, s[20:23], s46 offen offset:1024 sc1
    buffer_store_dwordx4 v[88:91], v3, s[20:23], s46 offen offset:2048 sc1
    buffer_store_dwordx4 v[92:95], v3, s[20:23], s46 offen offset:3072 sc1
oproj_sent:
    s_waitcnt vmcnt(0)
    s_barrier
    v_mov_b32 v16, 1
    s_lshl_b32 s3, s2, 7
    v_mov_b32 v17, s3
    s_xor_b32 s4, s2, 8
    s_lshl_b32 s4, s4, 7
    v_mov_b32 v18, s4
    s_cmp_lg_u32 s44, 0
    s_cbranch_scc1 oproj_poll
    s_mov_b64 exec, 1
    buffer_store_dword v16, v17, s[28:31], 0 offen sc1
    s_mov_b64 exec, -1
oproj_poll:
    s_mov_b32 s5, 0
oproj_poll_loop:
    buffer_load_dword v19, v18, s[28:31], 0 offen sc1
    s_waitcnt vmcnt(0)
    v_readfirstlane_b32 s3, v19
    s_add_u32 s5, s5, 1
    s_cmp_eq_u32 s3, 1
    s_cbranch_scc1 oproj_got
    s_sleep 1
    s_cmp_lt_u32 s5, 0x40000
    s_cbranch_scc1 oproj_poll_loop
oproj_got:
    s_mov_b32 s46, 4096
    buffer_load_dwordx4 v[96:99], v3, s[24:27], 0 offen offset:0 sc1
    buffer_load_dwordx4 v[100:103], v3, s[24:27], 0 offen offset:1024 sc1
    buffer_load_dwordx4 v[104:107], v3, s[24:27], 0 offen offset:2048 sc1
    buffer_load_dwordx4 v[108:111], v3, s[24:27], 0 offen offset:3072 sc1
    buffer_load_dwordx4 v[112:115], v3, s[24:27], s46 offen offset:0 sc1
    buffer_load_dwordx4 v[116:119], v3, s[24:27], s46 offen offset:1024 sc1
    buffer_load_dwordx4 v[120:123], v3, s[24:27], s46 offen offset:2048 sc1
    buffer_load_dwordx4 v[124:127], v3, s[24:27], s46 offen offset:3072 sc1
    v_and_b32 v16, 31, v0
    v_lshrrev_b32 v17, 5, v0
    v_lshlrev_b32 v16, 11, v16
    v_lshl_add_u32 v16, v17, 4, v16
    s_waitcnt vmcnt(0)
    v_add_f32 v32, v32, v96
    v_add_f32 v33, v33, v97
    v_add_f32 v34, v34, v98
    v_add_f32 v35, v35, v99
    v_add_f32 v36, v36, v100
    v_add_f32 v37, v37, v101
    v_add_f32 v38, v38, v102
    v_add_f32 v39, v39, v103
    v_add_f32 v40, v40, v104
    v_add_f32 v41, v41, v105
    v_add_f32 v42, v42, v106
    v_add_f32 v43, v43, v107
    v_add_f32 v44, v44, v108
    v_add_f32 v45, v45, v109
    v_add_f32 v46, v46, v110
    v_add_f32 v47, v47, v111
    v_add_f32 v48, v48, v112
    v_add_f32 v49, v49, v113
    v_add_f32 v50, v50, v114
    v_add_f32 v51, v51, v115
    v_add_f32 v52, v52, v116
    v_add_f32 v53, v53, v117
    v_add_f32 v54, v54, v118
    v_add_f32 v55, v55, v119
    v_add_f32 v56, v56, v120
    v_add_f32 v57, v57, v121
    v_add_f32 v58, v58, v122
    v_add_f32 v59, v59, v123
    v_add_f32 v60, v60, v124
    v_add_f32 v61, v61, v125
    v_add_f32 v62, v62, v126
    v_add_f32 v63, v63, v127
    v_cvt_pk_bf16_f32 v96, v32, v33
    v_cvt_pk_bf16_f32 v97, v34, v35
    v_cvt_pk_bf16_f32 v98, v36, v37
    v_cvt_pk_bf16_f32 v99, v38, v39
    v_cvt_pk_bf16_f32 v100, v40, v41
    v_cvt_pk_bf16_f32 v101, v42, v43
    v_cvt_pk_bf16_f32 v102, v44, v45
    v_cvt_pk_bf16_f32 v103, v46, v47
    v_cvt_pk_bf16_f32 v104, v48, v49
    v_cvt_pk_bf16_f32 v105, v50, v51
    v_cvt_pk_bf16_f32 v106, v52, v53
    v_cvt_pk_bf16_f32 v107, v54, v55
    v_cvt_pk_bf16_f32 v108, v56, v57
    v_cvt_pk_bf16_f32 v109, v58, v59
    v_cvt_pk_bf16_f32 v110, v60, v61
    v_cvt_pk_bf16_f32 v111, v62, v63
    buffer_store_dwordx4 v[96:99], v16, s[16:19], 0 offen offset:0
    buffer_store_dwordx4 v[100:103], v16, s[16:19], 0 offen offset:32
    buffer_store_dwordx4 v[104:107], v16, s[16:19], 0 offen offset:64
    buffer_store_dwordx4 v[108:111], v16, s[16:19], 0 offen offset:96
oproj_done:
    s_endpgm
.section .rodata,"a"
.p2align 6
.amdhsa_kernel attn_kernel
  .amdhsa_next_free_vgpr 384
  .amdhsa_next_free_sgpr 96
  .amdhsa_accum_offset 256
  .amdhsa_group_segment_fixed_size 0
  .amdhsa_kernarg_size 104
  .amdhsa_user_sgpr_count 2
  .amdhsa_user_sgpr_kernarg_segment_ptr 1
  .amdhsa_system_sgpr_workgroup_id_x 1
.end_amdhsa_kernel
.p2align 6
.amdhsa_kernel oproj_kernel
  .amdhsa_next_free_vgpr 288
  .amdhsa_next_free_sgpr 96
  .amdhsa_accum_offset 128
  .amdhsa_group_segment_fixed_size 0
  .amdhsa_kernarg_size 104
  .amdhsa_user_sgpr_count 2
  .amdhsa_user_sgpr_kernarg_segment_ptr 1
  .amdhsa_system_sgpr_workgroup_id_x 1
.end_amdhsa_kernel
```
